```python
import torch

def _softmax(x, axis=-1):
    return torch.softmax(x, dim=axis)
def _gelu(x):
    return torch.nn.functional.gelu(x, approximate="tanh")
def _silu(x):
    return torch.nn.functional.silu(x)
def _sigmoid(x):
    return torch.sigmoid(x)
def _layernorm(x, axis=-1, eps=1e-5):
    m = x.mean(dim=axis, keepdim=True)
    v = x.var(dim=axis, keepdim=True, unbiased=False)
    return (x - m) / torch.sqrt(v + eps)
def _scatter_add(tgt, idx, src, axis=0):
    return tgt.clone().index_add_(axis, idx, src)
def _segment_sum(src, seg, n):
    out = torch.zeros((n,) + src.shape[1:], dtype=src.dtype)
    return out.index_add_(0, seg, src)
def _pad(x, pw):
    flat = tuple(v for pair in reversed(pw) for v in pair)
    return torch.nn.functional.pad(x, flat)

kernel_name = 'parallel_sum__gqa_block_cached__swiglu_ffn__decode'

def setup_inputs():

    _w = (lambda a: (lambda t: t.to(torch.bfloat16) if t.is_floating_point() else t)(torch.as_tensor(a)))
    def _A_setup():
        B, Sq, D = 1, 1, 448
        Hq, Hkv, Sk, Dh = 16, 8, 32768, 256
        assert Hq % Hkv == 0, (Hq, Hkv)
        return {
            "x": _w((lambda *s: torch.randn(*s, dtype=torch.bfloat16) * 0.05)(B, Sq, D)),
            "k_cache": _w((lambda *s: torch.randn(*s, dtype=torch.bfloat16) * 3.2)(B, Hkv, Sk, Dh)),
            "v_cache": _w((lambda *s: torch.randn(*s, dtype=torch.bfloat16) * 1.6)(B, Hkv, Sk, Dh)),
            "wq": _w((lambda *s: torch.randn(*s, dtype=torch.bfloat16) * 3.2)(D, Hq * Dh) * (D ** -0.5)),
            "wo": _w((lambda *s: torch.randn(*s, dtype=torch.bfloat16) * 1.6)(Hq * Dh, D) * ((Hq * Dh) ** -0.5)),
        }
    _A_in = _A_setup()

    def _B_setup():
        B, S, D, F = 1, 1, 448, 1792
        return {
            "x": _w((lambda *s: torch.randn(*s, dtype=torch.bfloat16) * 0.05)(B, S, D)),
            "w_gate": _w((lambda *s: torch.randn(*s, dtype=torch.bfloat16) * 0.05)(D, F)),
            "w_up": _w((lambda *s: torch.randn(*s, dtype=torch.bfloat16) * 0.05)(D, F)),
            "w_down": _w((lambda *s: torch.randn(*s, dtype=torch.bfloat16) * 0.05)(F, D)),
        }
    _B_in = _B_setup()

    return {
        "A_x": _A_in["x"],
        "A_k_cache": _A_in["k_cache"],
        "A_v_cache": _A_in["v_cache"],
        "A_wq": _A_in["wq"],
        "A_wo": _A_in["wo"],
        "B_x": _B_in["x"],
        "B_w_gate": _B_in["w_gate"],
        "B_w_up": _B_in["w_up"],
        "B_w_down": _B_in["w_down"],
    }

def reference(A_x, A_k_cache, A_v_cache, A_wq, A_wo, B_x, B_w_gate, B_w_up, B_w_down):
    def _A_ref(x, k_cache, v_cache, wq, wo):
        B, Sq, D = x.shape
        Hq, Dh = 16, 256
        Hkv = k_cache.shape[1]
        rep = Hq // Hkv
        q = (lambda x, *d: x.permute(*d))((x @ wq).reshape(B, Sq, Hq, Dh), 0, 2, 1, 3)
        k = (lambda x, n, axis: torch.repeat_interleave(x, n, dim=axis))(k_cache, rep, axis=1)
        v = (lambda x, n, axis: torch.repeat_interleave(x, n, dim=axis))(v_cache, rep, axis=1)
        scores = torch.einsum("bhqd,bhkd->bhqk", q, k) * (Dh ** -0.5)
        p = _softmax(scores, axis=-1)
        o = torch.einsum("bhqk,bhkd->bhqd", p, v)
        return (lambda x, *d: x.permute(*d))(o, 0, 2, 1, 3).reshape(B, Sq, Hq * Dh) @ wo

    def _B_ref(x, w_gate, w_up, w_down):
        g = _silu(x @ w_gate)
        u = x @ w_up
        return (g * u) @ w_down

    x = A_x
    xn = _layernorm(x, axis=-1)
    return x + _A_ref(xn, A_k_cache, A_v_cache, A_wq, A_wo) + _B_ref(xn, B_w_gate, B_w_up, B_w_down)
```

```asm
; @launch grid=(256,1,1) block=(256,1,1) lds=44288
.amdgcn_target "amdgcn-amd-amdhsa--gfx950"
.text
.globl parallel_sum__gqa_block_cached__swiglu_ffn__decode_kernel
.p2align 8
.type parallel_sum__gqa_block_cached__swiglu_ffn__decode_kernel,@function
parallel_sum__gqa_block_cached__swiglu_ffn__decode_kernel:
  s_cmp_ge_u32 s2, 256
  s_cbranch_scc1 L_end
  s_load_dwordx16 s[4:19], s[0:1], 0
  s_load_dwordx8 s[20:27], s[0:1], 64
  v_and_b32 v1, 63, v0
  v_lshrrev_b32 v2, 6, v0
  v_lshlrev_b32 v57, 4, v0
  v_readfirstlane_b32 s3, v2
  s_lshr_b32 s56, s2, 3
  s_and_b32 s56, s56, 7
  s_lshr_b32 s57, s2, 6
  s_lshl_b32 s57, s57, 3
  s_and_b32 s72, s2, 7
  s_add_u32 s57, s57, s72
  s_mov_b32 s58, 0
  s_cmp_lt_u32 s57, 8
  s_cselect_b32 s58, 1, s58
  s_lshr_b32 s59, s57, 1
  s_and_b32 s59, s59, 3
  s_cmp_lt_u32 s56, 4
  s_cselect_b32 s74, 4, 3
  s_and_b32 s72, s57, 0x19
  s_cmp_eq_u32 s72, 8
  s_cselect_b32 s73, 2, s58
  s_cmp_lt_u32 s59, s74
  s_cselect_b32 s58, s73, s58
  s_mul_i32 s72, s56, s74
  s_add_u32 s59, s59, s72
  s_cmp_lt_u32 s56, 4
  s_cselect_b32 s72, 0, 4
  s_add_u32 s59, s59, s72
  s_mov_b32 s70, 0x3db8aa3b
  s_mov_b32 s66, 0x00ff00ff
  s_mov_b32 s67, 0xff00ff00
  s_cmp_eq_u32 s3, 3
  s_cselect_b32 s68, 0x00ff00ff, -1
  s_mov_b32 s69, s68
  v_lshrrev_b32 v8, 4, v1
  v_and_b32 v9, 15, v1
  v_and_b32 v10, 3, v1
  v_lshrrev_b32 v11, 2, v1
  v_and_b32 v12, 3, v11
  v_lshlrev_b32 v2, 9, v12
  v_lshl_add_u32 v2, v8, 6, v2
  v_lshl_add_u32 v2, v10, 4, v2
  v_lshlrev_b32 v3, 9, v8
  v_lshl_add_u32 v3, v9, 4, v3
  v_and_b32 v13, 1, v1
  v_lshlrev_b32 v13, 6, v13
  v_bfe_u32 v12, v1, 4, 1
  v_lshl_add_u32 v13, v12, 5, v13
  v_lshrrev_b32 v12, 5, v1
  v_lshl_add_u32 v13, v12, 4, v13
  v_lshrrev_b32 v12, 1, v9
  v_lshl_add_u32 v56, v12, 15, v13
  s_lshl_b32 s72, s3, 18
  v_add_u32 v56, s72, v56
  v_lshl_add_u32 v62, v12, 12, v13
  s_lshl_b32 s72, s3, 15
  v_add_u32 v62, s72, v62
  v_lshlrev_b32 v63, 4, v1
  v_lshrrev_b32 v58, 3, v0
  v_lshlrev_b32 v58, 12, v58
  v_and_b32 v16, 7, v0
  v_lshl_add_u32 v58, v16, 4, v58
  v_mov_b32 v60, 1
  v_mov_b32 v61, 0
  v_and_b32 v16, 1, v1
  v_lshlrev_b32 v16, 4, v16
  v_mov_b32 v18, 0xffff
  v_lshlrev_b32 v16, v16, v18
  v_bfe_u32 v18, v1, 1, 2
  v_cmp_eq_u32 vcc, 0, v18
  s_nop 1
  v_cndmask_b32 v4, 0, v16, vcc
  v_cmp_eq_u32 vcc, 1, v18
  s_nop 1
  v_cndmask_b32 v5, 0, v16, vcc
  v_cmp_eq_u32 vcc, 2, v18
  s_nop 1
  v_cndmask_b32 v6, 0, v16, vcc
  v_cmp_eq_u32 vcc, 3, v18
  s_nop 1
  v_cndmask_b32 v7, 0, v16, vcc
  s_waitcnt lgkmcnt(0)
  s_load_dword s60, s[26:27], 0
  s_lshl_b32 s24, s56, 5
  s_add_u32 s24, s24, s57
  s_mov_b32 s40, s4
  s_mov_b32 s41, s5
  s_mov_b32 s42, 0x380
  s_mov_b32 s43, 0x20000
  s_mov_b32 s36, s26
  s_mov_b32 s37, s27
  s_mov_b32 s38, 0x20000000
  s_mov_b32 s39, 0x20000
  s_mov_b32 s28, s6
  s_mov_b32 s29, s7
  s_mov_b32 s30, 0x8000000
  s_mov_b32 s31, 0x20000
  s_mov_b32 s32, s8
  s_mov_b32 s33, s9
  s_mov_b32 s34, 0x8000000
  s_mov_b32 s35, 0x20000
  s_mov_b32 s52, s22
  s_mov_b32 s53, s23
  s_mov_b32 s54, 0x380
  s_mov_b32 s55, 0x20000
  s_lshl_b32 s65, s56, 24
  s_lshl_b32 s72, s56, 12
  s_add_u32 s72, s72, 0x8000
  s_add_u32 s14, s26, s72
  s_addc_u32 s15, s27, 0
  s_cmp_eq_u32 s58, 0
  s_cbranch_scc1 L_stream
  buffer_load_dwordx4 v[52:55], v63, s[40:43], 0 offen
  v_bfe_u32 v12, v1, 3, 1
  v_lshl_add_u32 v12, v8, 1, v12
  v_and_b32 v13, 7, v1
  s_cmp_eq_u32 s58, 2
  s_cbranch_scc1 L_p0ffn
  s_mov_b32 s44, s10
  s_mov_b32 s45, s11
  s_mov_b32 s46, 0x380000
  s_mov_b32 s47, 0x20000
  v_lshlrev_b32 v14, 13, v12
  v_lshl_add_u32 v14, v13, 4, v14
  s_mul_i32 s72, s3, 917504
  s_lshl_b32 s73, s56, 10
  s_add_u32 s72, s72, s73
  s_lshl_b32 s73, s57, 7
  s_add_u32 s72, s72, s73
  buffer_load_dwordx4 a[0:3], v14, s[44:47], s72 offen nt
  s_add_u32 s72, s72, 65536
  buffer_load_dwordx4 a[4:7], v14, s[44:47], s72 offen nt
  s_add_u32 s72, s72, 65536
  buffer_load_dwordx4 a[8:11], v14, s[44:47], s72 offen nt
  s_add_u32 s72, s72, 65536
  buffer_load_dwordx4 a[12:15], v14, s[44:47], s72 offen nt
  s_add_u32 s72, s72, 65536
  buffer_load_dwordx4 a[16:19], v14, s[44:47], s72 offen nt
  s_add_u32 s72, s72, 65536
  buffer_load_dwordx4 a[20:23], v14, s[44:47], s72 offen nt
  s_add_u32 s72, s72, 65536
  buffer_load_dwordx4 a[24:27], v14, s[44:47], s72 offen nt
  s_add_u32 s72, s72, 65536
  buffer_load_dwordx4 a[28:31], v14, s[44:47], s72 offen nt
  s_add_u32 s72, s72, 65536
  buffer_load_dwordx4 a[32:35], v14, s[44:47], s72 offen nt
  s_add_u32 s72, s72, 65536
  buffer_load_dwordx4 a[36:39], v14, s[44:47], s72 offen nt
  s_add_u32 s72, s72, 65536
  buffer_load_dwordx4 a[40:43], v14, s[44:47], s72 offen nt
  s_add_u32 s72, s72, 65536
  buffer_load_dwordx4 a[44:47], v14, s[44:47], s72 offen nt
  s_add_u32 s72, s72, 65536
  buffer_load_dwordx4 a[48:51], v14, s[44:47], s72 offen nt
  s_add_u32 s72, s72, 65536
  buffer_load_dwordx4 a[52:55], v14, s[44:47], s72 offen nt
  s_lshl_b32 s72, s56, 12
  s_add_u32 s72, s72, 0x8000
  s_or_b32 s73, s57, s3
  s_cmp_lg_u32 s73, 0
  s_cbranch_scc1 L_p0ln
  s_mov_b64 exec, 1
  buffer_store_dword v61, v61, s[36:39], s72 offen sc1
  s_mov_b64 exec, -1
  s_branch L_p0ln
L_p0ffn:
  s_mov_b32 s44, s16
  s_mov_b32 s45, s17
  s_mov_b32 s46, 0x188000
  s_mov_b32 s47, 0x20000
  s_mov_b32 s48, s18
  s_mov_b32 s49, s19
  s_mov_b32 s50, 0x188000
  s_mov_b32 s51, 0x20000
  v_mul_u32_u24 v14, 3584, v12
  v_lshl_add_u32 v14, v13, 4, v14
  s_mul_i32 s72, s3, 401408
  s_lshl_b32 s73, s59, 7
  s_add_u32 s72, s72, s73
  buffer_load_dwordx4 a[0:3], v14, s[44:47], s72 offen nt
  buffer_load_dwordx4 a[56:59], v14, s[48:51], s72 offen nt
  s_add_u32 s72, s72, 28672
  buffer_load_dwordx4 a[4:7], v14, s[44:47], s72 offen nt
  buffer_load_dwordx4 a[60:63], v14, s[48:51], s72 offen nt
  s_add_u32 s72, s72, 28672
  buffer_load_dwordx4 a[8:11], v14, s[44:47], s72 offen nt
  buffer_load_dwordx4 a[64:67], v14, s[48:51], s72 offen nt
  s_add_u32 s72, s72, 28672
  buffer_load_dwordx4 a[12:15], v14, s[44:47], s72 offen nt
  buffer_load_dwordx4 a[68:71], v14, s[48:51], s72 offen nt
  s_add_u32 s72, s72, 28672
  buffer_load_dwordx4 a[16:19], v14, s[44:47], s72 offen nt
  buffer_load_dwordx4 a[72:75], v14, s[48:51], s72 offen nt
  s_add_u32 s72, s72, 28672
  buffer_load_dwordx4 a[20:23], v14, s[44:47], s72 offen nt
  buffer_load_dwordx4 a[76:79], v14, s[48:51], s72 offen nt
  s_add_u32 s72, s72, 28672
  buffer_load_dwordx4 a[24:27], v14, s[44:47], s72 offen nt
  buffer_load_dwordx4 a[80:83], v14, s[48:51], s72 offen nt
  s_add_u32 s72, s72, 28672
  buffer_load_dwordx4 a[28:31], v14, s[44:47], s72 offen nt
  buffer_load_dwordx4 a[84:87], v14, s[48:51], s72 offen nt
  s_add_u32 s72, s72, 28672
  buffer_load_dwordx4 a[32:35], v14, s[44:47], s72 offen nt
  buffer_load_dwordx4 a[88:91], v14, s[48:51], s72 offen nt
  s_add_u32 s72, s72, 28672
  buffer_load_dwordx4 a[36:39], v14, s[44:47], s72 offen nt
  buffer_load_dwordx4 a[92:95], v14, s[48:51], s72 offen nt
  s_add_u32 s72, s72, 28672
  buffer_load_dwordx4 a[40:43], v14, s[44:47], s72 offen nt
  buffer_load_dwordx4 a[96:99], v14, s[48:51], s72 offen nt
  s_add_u32 s72, s72, 28672
  buffer_load_dwordx4 a[44:47], v14, s[44:47], s72 offen nt
  buffer_load_dwordx4 a[100:103], v14, s[48:51], s72 offen nt
  s_add_u32 s72, s72, 28672
  buffer_load_dwordx4 a[48:51], v14, s[44:47], s72 offen nt
  buffer_load_dwordx4 a[104:107], v14, s[48:51], s72 offen nt
  s_add_u32 s72, s72, 28672
  buffer_load_dwordx4 a[52:55], v14, s[44:47], s72 offen nt
  buffer_load_dwordx4 a[108:111], v14, s[48:51], s72 offen nt
  s_mov_b32 s48, s20
  s_mov_b32 s49, s21
  s_mov_b32 s50, 0x188000
  s_mov_b32 s51, 0x20000
  v_mul_u32_u24 v15, 896, v8
  v_lshl_add_u32 v15, v9, 4, v15
  s_mul_i32 s72, s59, 57344
  s_lshl_b32 s73, s3, 8
  s_add_u32 s72, s72, s73
  buffer_load_dwordx4 a[128:131], v15, s[48:51], s72 offen nt
  s_add_u32 s72, s72, 3584
  buffer_load_dwordx4 a[132:135], v15, s[48:51], s72 offen nt
  s_add_u32 s72, s72, 3584
  buffer_load_dwordx4 a[136:139], v15, s[48:51], s72 offen nt
  s_add_u32 s72, s72, 3584
  buffer_load_dwordx4 a[140:143], v15, s[48:51], s72 offen nt
  s_add_u32 s72, s72, 3584
  buffer_load_dwordx4 a[144:147], v15, s[48:51], s72 offen nt
  s_add_u32 s72, s72, 3584
  buffer_load_dwordx4 a[148:151], v15, s[48:51], s72 offen nt
  s_add_u32 s72, s72, 3584
  buffer_load_dwordx4 a[152:155], v15, s[48:51], s72 offen nt
  s_add_u32 s72, s72, 3584
  buffer_load_dwordx4 a[156:159], v15, s[48:51], s72 offen nt
  s_add_u32 s72, s72, 3584
  buffer_load_dwordx4 a[160:163], v15, s[48:51], s72 offen nt
  s_add_u32 s72, s72, 3584
  buffer_load_dwordx4 a[164:167], v15, s[48:51], s72 offen nt
  s_add_u32 s72, s72, 3584
  buffer_load_dwordx4 a[168:171], v15, s[48:51], s72 offen nt
  s_add_u32 s72, s72, 3584
  buffer_load_dwordx4 a[172:175], v15, s[48:51], s72 offen nt
  s_add_u32 s72, s72, 3584
  buffer_load_dwordx4 a[176:179], v15, s[48:51], s72 offen nt
  s_add_u32 s72, s72, 3584
  buffer_load_dwordx4 a[180:183], v15, s[48:51], s72 offen nt
  s_add_u32 s72, s72, 3584
  buffer_load_dwordx4 a[184:187], v15, s[48:51], s72 offen nt
  s_add_u32 s72, s72, 3584
  buffer_load_dwordx4 a[188:191], v15, s[48:51], s72 offen nt
  s_waitcnt vmcnt(44)
  s_branch L_p0ln2
L_p0ln:
  s_waitcnt vmcnt(14)
L_p0ln2:
  v_lshlrev_b32 v24, 16, v52
  v_and_b32 v25, 0xffff0000, v52
  v_lshlrev_b32 v26, 16, v53
  v_and_b32 v27, 0xffff0000, v53
  v_lshlrev_b32 v28, 16, v54
  v_and_b32 v29, 0xffff0000, v54
  v_lshlrev_b32 v30, 16, v55
  v_and_b32 v31, 0xffff0000, v55
  v_add_f32 v16, v24, v25
  v_add_f32 v17, v26, v27
  v_add_f32 v18, v28, v29
  v_add_f32 v19, v30, v31
  v_add_f32 v16, v16, v17
  v_add_f32 v18, v18, v19
  v_add_f32 v16, v16, v18
  s_nop 1
  v_add_f32_dpp v16, v16, v16 row_ror:8 row_mask:0xf bank_mask:0xf
  s_nop 1
  v_add_f32_dpp v16, v16, v16 row_ror:4 row_mask:0xf bank_mask:0xf
  s_nop 1
  v_add_f32_dpp v16, v16, v16 row_ror:2 row_mask:0xf bank_mask:0xf
  s_nop 1
  v_add_f32_dpp v16, v16, v16 row_ror:1 row_mask:0xf bank_mask:0xf
  v_mov_b32 v17, v16
  s_nop 1
  v_permlane16_swap_b32 v17, v16
  s_nop 1
  v_add_f32 v16, v16, v17
  v_mov_b32 v17, v16
  s_nop 1
  v_permlane32_swap_b32 v17, v16
  s_nop 1
  v_add_f32 v16, v16, v17
  v_mul_f32 v16, 0x3b124925, v16
  v_sub_f32 v32, v24, v16
  v_sub_f32 v33, v25, v16
  v_sub_f32 v34, v26, v16
  v_sub_f32 v35, v27, v16
  v_sub_f32 v36, v28, v16
  v_sub_f32 v37, v29, v16
  v_sub_f32 v38, v30, v16
  v_sub_f32 v39, v31, v16
  v_mul_f32 v17, v32, v32
  v_fmac_f32 v17, v33, v33
  v_fmac_f32 v17, v34, v34
  v_fmac_f32 v17, v35, v35
  v_fmac_f32 v17, v36, v36
  v_fmac_f32 v17, v37, v37
  v_fmac_f32 v17, v38, v38
  v_fmac_f32 v17, v39, v39
  v_cmp_gt_u32 vcc, 56, v1
  s_nop 1
  v_cndmask_b32 v17, 0, v17, vcc
  s_nop 1
  v_add_f32_dpp v17, v17, v17 row_ror:8 row_mask:0xf bank_mask:0xf
  s_nop 1
  v_add_f32_dpp v17, v17, v17 row_ror:4 row_mask:0xf bank_mask:0xf
  s_nop 1
  v_add_f32_dpp v17, v17, v17 row_ror:2 row_mask:0xf bank_mask:0xf
  s_nop 1
  v_add_f32_dpp v17, v17, v17 row_ror:1 row_mask:0xf bank_mask:0xf
  v_mov_b32 v18, v17
  s_nop 1
  v_permlane16_swap_b32 v18, v17
  s_nop 1
  v_add_f32 v17, v17, v18
  v_mov_b32 v18, v17
  s_nop 1
  v_permlane32_swap_b32 v18, v17
  s_nop 1
  v_add_f32 v17, v17, v18
  v_mul_f32 v17, 0x3b124925, v17
  v_cvt_pk_bf16_f32 v16, v16, v16
  v_and_b32 v16, 0xffff0000, v16
  v_cvt_pk_bf16_f32 v17, v17, v17
  v_and_b32 v17, 0xffff0000, v17
  v_add_f32 v17, 0x3727c5ac, v17
  v_cvt_pk_bf16_f32 v17, v17, v17
  v_and_b32 v17, 0xffff0000, v17
  v_sqrt_f32 v17, v17
  s_nop 0
  v_cvt_pk_bf16_f32 v17, v17, v17
  v_and_b32 v17, 0xffff0000, v17
  v_rcp_f32 v18, v17
  v_sub_f32 v24, v24, v16
  v_sub_f32 v25, v25, v16
  v_sub_f32 v26, v26, v16
  v_sub_f32 v27, v27, v16
  v_sub_f32 v28, v28, v16
  v_sub_f32 v29, v29, v16
  v_sub_f32 v30, v30, v16
  v_sub_f32 v31, v31, v16
  v_cvt_pk_bf16_f32 v24, v24, v24
  v_and_b32 v24, 0xffff0000, v24
  v_cvt_pk_bf16_f32 v25, v25, v25
  v_and_b32 v25, 0xffff0000, v25
  v_cvt_pk_bf16_f32 v26, v26, v26
  v_and_b32 v26, 0xffff0000, v26
  v_cvt_pk_bf16_f32 v27, v27, v27
  v_and_b32 v27, 0xffff0000, v27
  v_cvt_pk_bf16_f32 v28, v28, v28
  v_and_b32 v28, 0xffff0000, v28
  v_cvt_pk_bf16_f32 v29, v29, v29
  v_and_b32 v29, 0xffff0000, v29
  v_cvt_pk_bf16_f32 v30, v30, v30
  v_and_b32 v30, 0xffff0000, v30
  v_cvt_pk_bf16_f32 v31, v31, v31
  v_and_b32 v31, 0xffff0000, v31
  v_mul_f32 v19, v24, v18
  v_fma_f32 v20, -v19, v17, v24
  v_fma_f32 v24, v20, v18, v19
  v_cvt_pk_bf16_f32 v24, v24, v24
  v_mul_f32 v19, v25, v18
  v_fma_f32 v20, -v19, v17, v25
  v_fma_f32 v25, v20, v18, v19
  v_cvt_pk_bf16_f32 v25, v25, v25
  v_mul_f32 v19, v26, v18
  v_fma_f32 v20, -v19, v17, v26
  v_fma_f32 v26, v20, v18, v19
  v_cvt_pk_bf16_f32 v26, v26, v26
  v_mul_f32 v19, v27, v18
  v_fma_f32 v20, -v19, v17, v27
  v_fma_f32 v27, v20, v18, v19
  v_cvt_pk_bf16_f32 v27, v27, v27
  v_mul_f32 v19, v28, v18
  v_fma_f32 v20, -v19, v17, v28
  v_fma_f32 v28, v20, v18, v19
  v_cvt_pk_bf16_f32 v28, v28, v28
  v_mul_f32 v19, v29, v18
  v_fma_f32 v20, -v19, v17, v29
  v_fma_f32 v29, v20, v18, v19
  v_cvt_pk_bf16_f32 v29, v29, v29
  v_mul_f32 v19, v30, v18
  v_fma_f32 v20, -v19, v17, v30
  v_fma_f32 v30, v20, v18, v19
  v_cvt_pk_bf16_f32 v30, v30, v30
  v_mul_f32 v19, v31, v18
  v_fma_f32 v20, -v19, v17, v31
  v_fma_f32 v31, v20, v18, v19
  v_cvt_pk_bf16_f32 v31, v31, v31
  v_lshlrev_b32 v19, 5, v1
  s_lshl_b32 s72, s3, 11
  v_add_u32 v19, s72, v19
  ds_write_b128 v19, v[24:27] offset:0
  ds_write_b128 v19, v[28:31] offset:16
  s_mul_i32 s73, s3, 448
  s_add_u32 s72, s72, s73
  v_lshlrev_b32 v19, 2, v12
  v_add_u32 v19, s72, v19
  s_waitcnt lgkmcnt(0)
  ds_read_b32 v24, v19 offset:0
  ds_read_b32 v25, v19 offset:32
  ds_read_b32 v26, v19 offset:64
  ds_read_b32 v27, v19 offset:96
  ds_read_b32 v28, v19 offset:128
  ds_read_b32 v29, v19 offset:160
  ds_read_b32 v30, v19 offset:192
  ds_read_b32 v31, v19 offset:224
  ds_read_b32 v32, v19 offset:256
  ds_read_b32 v33, v19 offset:288
  ds_read_b32 v34, v19 offset:320
  ds_read_b32 v35, v19 offset:352
  ds_read_b32 v36, v19 offset:384
  ds_read_b32 v37, v19 offset:416
  s_add_u32 s61, s60, 0x3c6ef372
  s_lshl_b32 s61, s61, 1
  s_or_b32 s61, s61, 1
  v_mov_b32 v59, s61
  s_waitcnt lgkmcnt(0)
  s_cmp_eq_u32 s58, 2
  s_cbranch_scc1 L_p0ffn2
  v_and_b32 v40, v4, v24
  v_and_b32 v41, v5, v24
  v_and_b32 v42, v6, v24
  v_and_b32 v43, v7, v24
  s_waitcnt vmcnt(13)
  s_nop 0
  v_mfma_f32_16x16x32_bf16 v[16:19], v[40:43], a[0:3], 0
  v_and_b32 v44, v4, v25
  v_and_b32 v45, v5, v25
  v_and_b32 v46, v6, v25
  v_and_b32 v47, v7, v25
  s_waitcnt vmcnt(12)
  s_nop 0
  v_mfma_f32_16x16x32_bf16 v[16:19], v[44:47], a[4:7], v[16:19]
  v_and_b32 v40, v4, v26
  v_and_b32 v41, v5, v26
  v_and_b32 v42, v6, v26
  v_and_b32 v43, v7, v26
  s_waitcnt vmcnt(11)
  s_nop 0
  v_mfma_f32_16x16x32_bf16 v[16:19], v[40:43], a[8:11], v[16:19]
  v_and_b32 v44, v4, v27
  v_and_b32 v45, v5, v27
  v_and_b32 v46, v6, v27
  v_and_b32 v47, v7, v27
  s_waitcnt vmcnt(10)
  s_nop 0
  v_mfma_f32_16x16x32_bf16 v[16:19], v[44:47], a[12:15], v[16:19]
  v_and_b32 v40, v4, v28
  v_and_b32 v41, v5, v28
  v_and_b32 v42, v6, v28
  v_and_b32 v43, v7, v28
  s_waitcnt vmcnt(9)
  s_nop 0
  v_mfma_f32_16x16x32_bf16 v[16:19], v[40:43], a[16:19], v[16:19]
  v_and_b32 v44, v4, v29
  v_and_b32 v45, v5, v29
  v_and_b32 v46, v6, v29
  v_and_b32 v47, v7, v29
  s_waitcnt vmcnt(8)
  s_nop 0
  v_mfma_f32_16x16x32_bf16 v[16:19], v[44:47], a[20:23], v[16:19]
  v_and_b32 v40, v4, v30
  v_and_b32 v41, v5, v30
  v_and_b32 v42, v6, v30
  v_and_b32 v43, v7, v30
  s_waitcnt vmcnt(7)
  s_nop 0
  v_mfma_f32_16x16x32_bf16 v[16:19], v[40:43], a[24:27], v[16:19]
  v_and_b32 v44, v4, v31
  v_and_b32 v45, v5, v31
  v_and_b32 v46, v6, v31
  v_and_b32 v47, v7, v31
  s_waitcnt vmcnt(6)
  s_nop 0
  v_mfma_f32_16x16x32_bf16 v[16:19], v[44:47], a[28:31], v[16:19]
  v_and_b32 v40, v4, v32
  v_and_b32 v41, v5, v32
  v_and_b32 v42, v6, v32
  v_and_b32 v43, v7, v32
  s_waitcnt vmcnt(5)
  s_nop 0
  v_mfma_f32_16x16x32_bf16 v[16:19], v[40:43], a[32:35], v[16:19]
  v_and_b32 v44, v4, v33
  v_and_b32 v45, v5, v33
  v_and_b32 v46, v6, v33
  v_and_b32 v47, v7, v33
  s_waitcnt vmcnt(4)
  s_nop 0
  v_mfma_f32_16x16x32_bf16 v[16:19], v[44:47], a[36:39], v[16:19]
  v_and_b32 v40, v4, v34
  v_and_b32 v41, v5, v34
  v_and_b32 v42, v6, v34
  v_and_b32 v43, v7, v34
  s_waitcnt vmcnt(3)
  s_nop 0
  v_mfma_f32_16x16x32_bf16 v[16:19], v[40:43], a[40:43], v[16:19]
  v_and_b32 v44, v4, v35
  v_and_b32 v45, v5, v35
  v_and_b32 v46, v6, v35
  v_and_b32 v47, v7, v35
  s_waitcnt vmcnt(2)
  s_nop 0
  v_mfma_f32_16x16x32_bf16 v[16:19], v[44:47], a[44:47], v[16:19]
  v_and_b32 v40, v4, v36
  v_and_b32 v41, v5, v36
  v_and_b32 v42, v6, v36
  v_and_b32 v43, v7, v36
  s_waitcnt vmcnt(1)
  s_nop 0
  v_mfma_f32_16x16x32_bf16 v[16:19], v[40:43], a[48:51], v[16:19]
  v_and_b32 v44, v4, v37
  v_and_b32 v45, v5, v37
  v_and_b32 v46, v6, v37
  v_and_b32 v47, v7, v37
  s_waitcnt vmcnt(0)
  s_nop 0
  v_mfma_f32_16x16x32_bf16 v[16:19], v[44:47], a[52:55], v[16:19]
  v_lshlrev_b32 v14, 5, v13
  v_bfe_u32 v15, v1, 4, 1
  v_lshl_add_u32 v14, v15, 4, v14
  v_bfe_u32 v15, v1, 3, 1
  v_lshl_add_u32 v14, v15, 8, v14
  s_lshl_b32 s72, s3, 9
  v_add_u32 v14, s72, v14
  s_nop 1
  s_mov_b64 exec, s[66:67]
  ds_write_b128 v14, v[16:19] offset:8192
  s_mov_b64 exec, -1
  s_waitcnt lgkmcnt(0)
  s_barrier
  s_cmp_lg_u32 s3, 0
  s_cbranch_scc1 L_stream
  v_lshlrev_b32 v14, 2, v1
  ds_read_b32 v24, v14 offset:8192
  ds_read_b32 v25, v14 offset:8448
  ds_read_b32 v26, v14 offset:8704
  ds_read_b32 v27, v14 offset:8960
  ds_read_b32 v28, v14 offset:9216
  ds_read_b32 v29, v14 offset:9472
  ds_read_b32 v30, v14 offset:9728
  ds_read_b32 v31, v14 offset:9984
  s_waitcnt lgkmcnt(0)
  v_add_f32 v24, v24, v28
  v_add_f32 v25, v25, v29
  v_add_f32 v26, v26, v30
  v_add_f32 v27, v27, v31
  v_add_f32 v24, v24, v26
  v_add_f32 v25, v25, v27
  v_add_f32 v24, v24, v25
  s_nop 1
  v_mov_b32_dpp v25, v24 quad_perm:[1,0,3,2] row_mask:0xf bank_mask:0xf
  v_cvt_pk_bf16_f32 v28, v24, v25
  v_mov_b32 v29, v59
  s_lshl_b32 s72, s56, 11
  s_lshl_b32 s73, s57, 8
  s_add_u32 s72, s72, s73
  s_add_u32 s72, s72, 0x1000
  s_mov_b32 exec_lo, 0x55555555
  s_mov_b32 exec_hi, 0x55555555
  buffer_store_dwordx2 v[28:29], v14, s[36:39], s72 offen sc1
  s_mov_b64 exec, -1
  s_branch L_stream
L_p0ffn2:
  v_and_b32 v40, v4, v24
  v_and_b32 v41, v5, v24
  v_and_b32 v42, v6, v24
  v_and_b32 v43, v7, v24
  s_waitcnt vmcnt(42)
  s_nop 0
  v_mfma_f32_16x16x32_bf16 v[16:19], v[40:43], a[0:3], 0
  v_mfma_f32_16x16x32_bf16 v[20:23], v[40:43], a[56:59], 0
  v_and_b32 v44, v4, v25
  v_and_b32 v45, v5, v25
  v_and_b32 v46, v6, v25
  v_and_b32 v47, v7, v25
  s_waitcnt vmcnt(40)
  s_nop 0
  v_mfma_f32_16x16x32_bf16 v[16:19], v[44:47], a[4:7], v[16:19]
  v_mfma_f32_16x16x32_bf16 v[20:23], v[44:47], a[60:63], v[20:23]
  v_and_b32 v40, v4, v26
  v_and_b32 v41, v5, v26
  v_and_b32 v42, v6, v26
  v_and_b32 v43, v7, v26
  s_waitcnt vmcnt(38)
  s_nop 0
  v_mfma_f32_16x16x32_bf16 v[16:19], v[40:43], a[8:11], v[16:19]
  v_mfma_f32_16x16x32_bf16 v[20:23], v[40:43], a[64:67], v[20:23]
  v_and_b32 v44, v4, v27
  v_and_b32 v45, v5, v27
  v_and_b32 v46, v6, v27
  v_and_b32 v47, v7, v27
  s_waitcnt vmcnt(36)
  s_nop 0
  v_mfma_f32_16x16x32_bf16 v[16:19], v[44:47], a[12:15], v[16:19]
  v_mfma_f32_16x16x32_bf16 v[20:23], v[44:47], a[68:71], v[20:23]
  v_and_b32 v40, v4, v28
  v_and_b32 v41, v5, v28
  v_and_b32 v42, v6, v28
  v_and_b32 v43, v7, v28
  s_waitcnt vmcnt(34)
  s_nop 0
  v_mfma_f32_16x16x32_bf16 v[16:19], v[40:43], a[16:19], v[16:19]
  v_mfma_f32_16x16x32_bf16 v[20:23], v[40:43], a[72:75], v[20:23]
  v_and_b32 v44, v4, v29
  v_and_b32 v45, v5, v29
  v_and_b32 v46, v6, v29
  v_and_b32 v47, v7, v29
  s_waitcnt vmcnt(32)
  s_nop 0
  v_mfma_f32_16x16x32_bf16 v[16:19], v[44:47], a[20:23], v[16:19]
  v_mfma_f32_16x16x32_bf16 v[20:23], v[44:47], a[76:79], v[20:23]
  v_and_b32 v40, v4, v30
  v_and_b32 v41, v5, v30
  v_and_b32 v42, v6, v30
  v_and_b32 v43, v7, v30
  s_waitcnt vmcnt(30)
  s_nop 0
  v_mfma_f32_16x16x32_bf16 v[16:19], v[40:43], a[24:27], v[16:19]
  v_mfma_f32_16x16x32_bf16 v[20:23], v[40:43], a[80:83], v[20:23]
  v_and_b32 v44, v4, v31
  v_and_b32 v45, v5, v31
  v_and_b32 v46, v6, v31
  v_and_b32 v47, v7, v31
  s_waitcnt vmcnt(28)
  s_nop 0
  v_mfma_f32_16x16x32_bf16 v[16:19], v[44:47], a[28:31], v[16:19]
  v_mfma_f32_16x16x32_bf16 v[20:23], v[44:47], a[84:87], v[20:23]
  v_and_b32 v40, v4, v32
  v_and_b32 v41, v5, v32
  v_and_b32 v42, v6, v32
  v_and_b32 v43, v7, v32
  s_waitcnt vmcnt(26)
  s_nop 0
  v_mfma_f32_16x16x32_bf16 v[16:19], v[40:43], a[32:35], v[16:19]
  v_mfma_f32_16x16x32_bf16 v[20:23], v[40:43], a[88:91], v[20:23]
  v_and_b32 v44, v4, v33
  v_and_b32 v45, v5, v33
  v_and_b32 v46, v6, v33
  v_and_b32 v47, v7, v33
  s_waitcnt vmcnt(24)
  s_nop 0
  v_mfma_f32_16x16x32_bf16 v[16:19], v[44:47], a[36:39], v[16:19]
  v_mfma_f32_16x16x32_bf16 v[20:23], v[44:47], a[92:95], v[20:23]
  v_and_b32 v40, v4, v34
  v_and_b32 v41, v5, v34
  v_and_b32 v42, v6, v34
  v_and_b32 v43, v7, v34
  s_waitcnt vmcnt(22)
  s_nop 0
  v_mfma_f32_16x16x32_bf16 v[16:19], v[40:43], a[40:43], v[16:19]
  v_mfma_f32_16x16x32_bf16 v[20:23], v[40:43], a[96:99], v[20:23]
  v_and_b32 v44, v4, v35
  v_and_b32 v45, v5, v35
  v_and_b32 v46, v6, v35
  v_and_b32 v47, v7, v35
  s_waitcnt vmcnt(20)
  s_nop 0
  v_mfma_f32_16x16x32_bf16 v[16:19], v[44:47], a[44:47], v[16:19]
  v_mfma_f32_16x16x32_bf16 v[20:23], v[44:47], a[100:103], v[20:23]
  v_and_b32 v40, v4, v36
  v_and_b32 v41, v5, v36
  v_and_b32 v42, v6, v36
  v_and_b32 v43, v7, v36
  s_waitcnt vmcnt(18)
  s_nop 0
  v_mfma_f32_16x16x32_bf16 v[16:19], v[40:43], a[48:51], v[16:19]
  v_mfma_f32_16x16x32_bf16 v[20:23], v[40:43], a[104:107], v[20:23]
  v_and_b32 v44, v4, v37
  v_and_b32 v45, v5, v37
  v_and_b32 v46, v6, v37
  v_and_b32 v47, v7, v37
  s_waitcnt vmcnt(16)
  s_nop 0
  v_mfma_f32_16x16x32_bf16 v[16:19], v[44:47], a[52:55], v[16:19]
  v_mfma_f32_16x16x32_bf16 v[20:23], v[44:47], a[108:111], v[20:23]
  v_lshlrev_b32 v14, 5, v13
  v_bfe_u32 v15, v1, 4, 1
  v_lshl_add_u32 v14, v15, 4, v14
  v_bfe_u32 v15, v1, 3, 1
  v_lshl_add_u32 v14, v15, 8, v14
  s_lshl_b32 s72, s3, 9
  v_add_u32 v14, s72, v14
  s_nop 1
  s_mov_b64 exec, s[66:67]
  ds_write_b128 v14, v[16:19] offset:8192
  ds_write_b128 v14, v[20:23] offset:10240
  s_mov_b64 exec, -1
  s_waitcnt lgkmcnt(0)
  s_barrier
  v_lshlrev_b32 v14, 2, v1
  ds_read_b32 v24, v14 offset:8192
  ds_read_b32 v25, v14 offset:8448
  ds_read_b32 v26, v14 offset:8704
  ds_read_b32 v27, v14 offset:8960
  ds_read_b32 v28, v14 offset:9216
  ds_read_b32 v29, v14 offset:9472
  ds_read_b32 v30, v14 offset:9728
  ds_read_b32 v31, v14 offset:9984
  ds_read_b32 v32, v14 offset:10240
  ds_read_b32 v33, v14 offset:10496
  ds_read_b32 v34, v14 offset:10752
  ds_read_b32 v35, v14 offset:11008
  ds_read_b32 v36, v14 offset:11264
  ds_read_b32 v37, v14 offset:11520
  ds_read_b32 v38, v14 offset:11776
  ds_read_b32 v39, v14 offset:12032
  s_waitcnt lgkmcnt(0)
  v_add_f32 v24, v24, v28
  v_add_f32 v32, v32, v36
  v_add_f32 v25, v25, v29
  v_add_f32 v33, v33, v37
  v_add_f32 v26, v26, v30
  v_add_f32 v34, v34, v38
  v_add_f32 v27, v27, v31
  v_add_f32 v35, v35, v39
  v_add_f32 v24, v24, v26
  v_add_f32 v32, v32, v34
  v_add_f32 v25, v25, v27
  v_add_f32 v33, v33, v35
  v_add_f32 v24, v24, v25
  v_add_f32 v32, v32, v33
  v_cvt_pk_bf16_f32 v24, v24, v24
  v_and_b32 v24, 0xffff0000, v24
  v_cvt_pk_bf16_f32 v32, v32, v32
  v_and_b32 v32, 0xffff0000, v32
  v_mul_f32 v27, 0xbfb8aa3b, v24
  v_exp_f32 v27, v27
  s_nop 0
  v_add_f32 v27, 1.0, v27
  v_rcp_f32 v27, v27
  s_nop 0
  v_mul_f32 v24, v24, v27
  v_cvt_pk_bf16_f32 v24, v24, v24
  v_and_b32 v24, 0xffff0000, v24
  v_mul_f32 v24, v24, v32
  v_cvt_pk_bf16_f32 v24, v24, v24
  s_lshl_b32 s72, s3, 8
  v_add_u32 v14, s72, v14
  ds_write_b32 v14, v24 offset:12288
  v_lshlrev_b32 v14, 2, v8
  v_add_u32 v14, s72, v14
  s_waitcnt lgkmcnt(0)
  ds_read_b32 v24, v14 offset:12288
  ds_read_b32 v25, v14 offset:12304
  ds_read_b32 v26, v14 offset:12320
  ds_read_b32 v27, v14 offset:12336
  ds_read_b32 v28, v14 offset:12352
  ds_read_b32 v29, v14 offset:12368
  ds_read_b32 v30, v14 offset:12384
  ds_read_b32 v31, v14 offset:12400
  ds_read_b32 v32, v14 offset:12416
  ds_read_b32 v33, v14 offset:12432
  ds_read_b32 v34, v14 offset:12448
  ds_read_b32 v35, v14 offset:12464
  ds_read_b32 v36, v14 offset:12480
  ds_read_b32 v37, v14 offset:12496
  ds_read_b32 v38, v14 offset:12512
  ds_read_b32 v39, v14 offset:12528
  s_waitcnt lgkmcnt(0)
  v_and_b32 v40, v4, v24
  v_and_b32 v41, v5, v24
  v_and_b32 v42, v6, v24
  v_and_b32 v43, v7, v24
  s_waitcnt vmcnt(15)
  s_nop 0
  v_mfma_f32_16x16x32_bf16 v[16:19], v[40:43], a[128:131], 0
  v_and_b32 v44, v4, v25
  v_and_b32 v45, v5, v25
  v_and_b32 v46, v6, v25
  v_and_b32 v47, v7, v25
  s_waitcnt vmcnt(14)
  s_nop 0
  v_mfma_f32_16x16x32_bf16 v[16:19], v[44:47], a[132:135], v[16:19]
  v_and_b32 v40, v4, v26
  v_and_b32 v41, v5, v26
  v_and_b32 v42, v6, v26
  v_and_b32 v43, v7, v26
  s_waitcnt vmcnt(13)
  s_nop 0
  v_mfma_f32_16x16x32_bf16 v[16:19], v[40:43], a[136:139], v[16:19]
  v_and_b32 v44, v4, v27
  v_and_b32 v45, v5, v27
  v_and_b32 v46, v6, v27
  v_and_b32 v47, v7, v27
  s_waitcnt vmcnt(12)
  s_nop 0
  v_mfma_f32_16x16x32_bf16 v[16:19], v[44:47], a[140:143], v[16:19]
  v_and_b32 v40, v4, v28
  v_and_b32 v41, v5, v28
  v_and_b32 v42, v6, v28
  v_and_b32 v43, v7, v28
  s_waitcnt vmcnt(11)
  s_nop 0
  v_mfma_f32_16x16x32_bf16 v[16:19], v[40:43], a[144:147], v[16:19]
  v_and_b32 v44, v4, v29
  v_and_b32 v45, v5, v29
  v_and_b32 v46, v6, v29
  v_and_b32 v47, v7, v29
  s_waitcnt vmcnt(10)
  s_nop 0
  v_mfma_f32_16x16x32_bf16 v[16:19], v[44:47], a[148:151], v[16:19]
  v_and_b32 v40, v4, v30
  v_and_b32 v41, v5, v30
  v_and_b32 v42, v6, v30
  v_and_b32 v43, v7, v30
  s_waitcnt vmcnt(9)
  s_nop 0
  v_mfma_f32_16x16x32_bf16 v[16:19], v[40:43], a[152:155], v[16:19]
  v_and_b32 v44, v4, v31
  v_and_b32 v45, v5, v31
  v_and_b32 v46, v6, v31
  v_and_b32 v47, v7, v31
  s_waitcnt vmcnt(8)
  s_nop 0
  v_mfma_f32_16x16x32_bf16 v[16:19], v[44:47], a[156:159], v[16:19]
  v_and_b32 v40, v4, v32
  v_and_b32 v41, v5, v32
  v_and_b32 v42, v6, v32
  v_and_b32 v43, v7, v32
  s_waitcnt vmcnt(7)
  s_nop 0
  v_mfma_f32_16x16x32_bf16 v[16:19], v[40:43], a[160:163], v[16:19]
  v_and_b32 v44, v4, v33
  v_and_b32 v45, v5, v33
  v_and_b32 v46, v6, v33
  v_and_b32 v47, v7, v33
  s_waitcnt vmcnt(6)
  s_nop 0
  v_mfma_f32_16x16x32_bf16 v[16:19], v[44:47], a[164:167], v[16:19]
  v_and_b32 v40, v4, v34
  v_and_b32 v41, v5, v34
  v_and_b32 v42, v6, v34
  v_and_b32 v43, v7, v34
  s_waitcnt vmcnt(5)
  s_nop 0
  v_mfma_f32_16x16x32_bf16 v[16:19], v[40:43], a[168:171], v[16:19]
  v_and_b32 v44, v4, v35
  v_and_b32 v45, v5, v35
  v_and_b32 v46, v6, v35
  v_and_b32 v47, v7, v35
  s_waitcnt vmcnt(4)
  s_nop 0
  v_mfma_f32_16x16x32_bf16 v[16:19], v[44:47], a[172:175], v[16:19]
  v_and_b32 v40, v4, v36
  v_and_b32 v41, v5, v36
  v_and_b32 v42, v6, v36
  v_and_b32 v43, v7, v36
  s_waitcnt vmcnt(3)
  s_nop 0
  v_mfma_f32_16x16x32_bf16 v[16:19], v[40:43], a[176:179], v[16:19]
  v_and_b32 v44, v4, v37
  v_and_b32 v45, v5, v37
  v_and_b32 v46, v6, v37
  v_and_b32 v47, v7, v37
  s_waitcnt vmcnt(2)
  s_nop 0
  v_mfma_f32_16x16x32_bf16 v[16:19], v[44:47], a[180:183], v[16:19]
  v_and_b32 v40, v4, v38
  v_and_b32 v41, v5, v38
  v_and_b32 v42, v6, v38
  v_and_b32 v43, v7, v38
  s_waitcnt vmcnt(1)
  s_nop 0
  v_mfma_f32_16x16x32_bf16 v[16:19], v[40:43], a[184:187], v[16:19]
  v_and_b32 v44, v4, v39
  v_and_b32 v45, v5, v39
  v_and_b32 v46, v6, v39
  v_and_b32 v47, v7, v39
  s_waitcnt vmcnt(0)
  s_nop 0
  v_mfma_f32_16x16x32_bf16 v[16:19], v[44:47], a[188:191], v[16:19]
  s_lshl_b32 s72, s59, 7
  s_add_u32 s72, s72, 0x10000
  s_nop 7
  v_permlane32_swap_b32 v16, v18
  v_permlane32_swap_b32 v17, v19
  v_mov_b32 v25, v59
  v_mov_b32 v27, v59
  v_mov_b32 v24, v16
  v_mov_b32 v26, v17
  s_mov_b64 exec, s[68:69]
  buffer_store_dwordx4 v[24:27], v62, s[36:39], s72 offen sc1
  s_mov_b64 exec, -1
L_stream:
  s_mov_b32 s44, s12
  s_mov_b32 s45, s13
  s_mov_b32 s46, 0x380000
  s_mov_b32 s47, 0x20000
  s_mov_b32 s64, 29
  s_cmp_eq_u32 s58, 1
  s_cselect_b32 s64, 27, s64
  s_cmp_eq_u32 s58, 2
  s_cselect_b32 s64, 21, s64
  s_mov_b32 s99, 136
  s_cmp_lt_u32 s56, 4
  s_cselect_b32 s99, 144, s99
  s_mul_i32 s75, s57, 475136
  s_add_u32 s75, s75, s65
  s_mov_b32 s97, s75
  s_mov_b32 s101, 1
  s_mov_b32 s13, 0
  s_cmp_eq_u32 s3, 0
  s_cbranch_scc1 L_w0
  s_sub_u32 s72, s3, 1
  s_lshl_b32 s72, s72, 14
  s_add_u32 s25, s75, s72
  s_add_u32 s98, s25, 49152
  s_mov_b32 s62, s25
  s_add_u32 s63, s62, 4096
  s_add_u32 s76, s62, 8192
  s_add_u32 s77, s62, 12288
  buffer_load_dwordx4 a[0:3], v2, s[28:31], s62 offen offset:0 nt
  buffer_load_dwordx4 a[4:7], v2, s[28:31], s62 offen offset:256 nt
  buffer_load_dwordx4 a[8:11], v2, s[28:31], s62 offen offset:2048 nt
  buffer_load_dwordx4 a[12:15], v2, s[28:31], s62 offen offset:2304 nt
  buffer_load_dwordx4 a[16:19], v2, s[28:31], s63 offen offset:0 nt
  buffer_load_dwordx4 a[20:23], v2, s[28:31], s63 offen offset:256 nt
  buffer_load_dwordx4 a[24:27], v2, s[28:31], s63 offen offset:2048 nt
  buffer_load_dwordx4 a[28:31], v2, s[28:31], s63 offen offset:2304 nt
  buffer_load_dwordx4 a[32:35], v2, s[28:31], s76 offen offset:0 nt
  buffer_load_dwordx4 a[36:39], v2, s[28:31], s76 offen offset:256 nt
  buffer_load_dwordx4 a[40:43], v2, s[28:31], s76 offen offset:2048 nt
  buffer_load_dwordx4 a[44:47], v2, s[28:31], s76 offen offset:2304 nt
  buffer_load_dwordx4 a[48:51], v2, s[28:31], s77 offen offset:0 nt
  buffer_load_dwordx4 a[52:55], v2, s[28:31], s77 offen offset:256 nt
  buffer_load_dwordx4 a[56:59], v2, s[28:31], s77 offen offset:2048 nt
  buffer_load_dwordx4 a[60:63], v2, s[28:31], s77 offen offset:2304 nt
  s_mov_b32 s62, s25
  s_add_u32 s63, s62, 4096
  s_add_u32 s76, s62, 8192
  s_add_u32 s77, s62, 12288
  buffer_load_dwordx4 a[64:67], v3, s[32:35], s62 offen offset:0 nt
  buffer_load_dwordx4 a[68:71], v3, s[32:35], s62 offen offset:256 nt
  buffer_load_dwordx4 a[72:75], v3, s[32:35], s62 offen offset:2048 nt
  buffer_load_dwordx4 a[76:79], v3, s[32:35], s62 offen offset:2304 nt
  buffer_load_dwordx4 a[80:83], v3, s[32:35], s63 offen offset:0 nt
  buffer_load_dwordx4 a[84:87], v3, s[32:35], s63 offen offset:256 nt
  buffer_load_dwordx4 a[88:91], v3, s[32:35], s63 offen offset:2048 nt
  buffer_load_dwordx4 a[92:95], v3, s[32:35], s63 offen offset:2304 nt
  buffer_load_dwordx4 a[96:99], v3, s[32:35], s76 offen offset:0 nt
  buffer_load_dwordx4 a[100:103], v3, s[32:35], s76 offen offset:256 nt
  buffer_load_dwordx4 a[104:107], v3, s[32:35], s76 offen offset:2048 nt
  buffer_load_dwordx4 a[108:111], v3, s[32:35], s76 offen offset:2304 nt
  buffer_load_dwordx4 a[112:115], v3, s[32:35], s77 offen offset:0 nt
  buffer_load_dwordx4 a[116:119], v3, s[32:35], s77 offen offset:256 nt
  buffer_load_dwordx4 a[120:123], v3, s[32:35], s77 offen offset:2048 nt
  buffer_load_dwordx4 a[124:127], v3, s[32:35], s77 offen offset:2304 nt
  s_mov_b32 s62, s98
  s_add_u32 s63, s62, 4096
  s_add_u32 s76, s62, 8192
  s_add_u32 s77, s62, 12288
  buffer_load_dwordx4 a[128:131], v2, s[28:31], s62 offen offset:0 nt
  buffer_load_dwordx4 a[132:135], v2, s[28:31], s62 offen offset:256 nt
  buffer_load_dwordx4 a[136:139], v2, s[28:31], s62 offen offset:2048 nt
  buffer_load_dwordx4 a[140:143], v2, s[28:31], s62 offen offset:2304 nt
  buffer_load_dwordx4 a[144:147], v2, s[28:31], s63 offen offset:0 nt
  buffer_load_dwordx4 a[148:151], v2, s[28:31], s63 offen offset:256 nt
  buffer_load_dwordx4 a[152:155], v2, s[28:31], s63 offen offset:2048 nt
  buffer_load_dwordx4 a[156:159], v2, s[28:31], s63 offen offset:2304 nt
  buffer_load_dwordx4 a[160:163], v2, s[28:31], s76 offen offset:0 nt
  buffer_load_dwordx4 a[164:167], v2, s[28:31], s76 offen offset:256 nt
  buffer_load_dwordx4 a[168:171], v2, s[28:31], s76 offen offset:2048 nt
  buffer_load_dwordx4 a[172:175], v2, s[28:31], s76 offen offset:2304 nt
  buffer_load_dwordx4 a[176:179], v2, s[28:31], s77 offen offset:0 nt
  buffer_load_dwordx4 a[180:183], v2, s[28:31], s77 offen offset:256 nt
  buffer_load_dwordx4 a[184:187], v2, s[28:31], s77 offen offset:2048 nt
  buffer_load_dwordx4 a[188:191], v2, s[28:31], s77 offen offset:2304 nt
  s_waitcnt lgkmcnt(0)
  s_add_u32 s61, s60, 0x3c6ef372
  s_lshl_b32 s61, s61, 1
  s_or_b32 s61, s61, 1
  v_mov_b32 v59, s61
  s_barrier
  v_lshlrev_b32 v16, 5, v1
  ds_read_b128 v[8:11], v16 offset:13312
  ds_read_b128 v[12:15], v16 offset:13328
  s_branch L_init
L_w0:
  s_add_u32 s25, s75, 98304
  s_add_u32 s98, s75, 114688
  s_getpc_b64 s[4:5]
L_pc:
  v_mov_b32 v16, v63
  global_load_dwordx4 a[64:67], v16, s[4:5]
  v_add_u32 v16, 0x400, v16
  global_load_dwordx4 a[68:71], v16, s[4:5]
  v_add_u32 v16, 0x400, v16
  global_load_dwordx4 a[72:75], v16, s[4:5]
  v_add_u32 v16, 0x400, v16
  global_load_dwordx4 a[76:79], v16, s[4:5]
  v_add_u32 v16, 0x400, v16
  global_load_dwordx4 a[80:83], v16, s[4:5]
  v_add_u32 v16, 0x400, v16
  global_load_dwordx4 a[84:87], v16, s[4:5]
  v_add_u32 v16, 0x400, v16
  global_load_dwordx4 a[88:91], v16, s[4:5]
  s_mov_b32 s62, s25
  s_add_u32 s63, s62, 4096
  s_add_u32 s76, s62, 8192
  s_add_u32 s77, s62, 12288
  buffer_load_dwordx4 a[0:3], v2, s[28:31], s62 offen offset:0 nt
  buffer_load_dwordx4 a[4:7], v2, s[28:31], s62 offen offset:256 nt
  buffer_load_dwordx4 a[8:11], v2, s[28:31], s62 offen offset:2048 nt
  buffer_load_dwordx4 a[12:15], v2, s[28:31], s62 offen offset:2304 nt
  buffer_load_dwordx4 a[16:19], v2, s[28:31], s63 offen offset:0 nt
  buffer_load_dwordx4 a[20:23], v2, s[28:31], s63 offen offset:256 nt
  buffer_load_dwordx4 a[24:27], v2, s[28:31], s63 offen offset:2048 nt
  buffer_load_dwordx4 a[28:31], v2, s[28:31], s63 offen offset:2304 nt
  buffer_load_dwordx4 a[32:35], v2, s[28:31], s76 offen offset:0 nt
  buffer_load_dwordx4 a[36:39], v2, s[28:31], s76 offen offset:256 nt
  buffer_load_dwordx4 a[40:43], v2, s[28:31], s76 offen offset:2048 nt
  buffer_load_dwordx4 a[44:47], v2, s[28:31], s76 offen offset:2304 nt
  buffer_load_dwordx4 a[48:51], v2, s[28:31], s77 offen offset:0 nt
  buffer_load_dwordx4 a[52:55], v2, s[28:31], s77 offen offset:256 nt
  buffer_load_dwordx4 a[56:59], v2, s[28:31], s77 offen offset:2048 nt
  buffer_load_dwordx4 a[60:63], v2, s[28:31], s77 offen offset:2304 nt
  v_mov_b32 v16, 8
  ds_write_b32 v61, v16 offset:15360
  ds_write_b32 v61, v61 offset:15364
  v_lshlrev_b32 v16, 2, v1
  ds_write_b32 v16, v61 offset:43264
  ds_write_b32 v16, v61 offset:43520
  ds_write_b32 v16, v61 offset:43776
  ds_write_b32 v16, v61 offset:44032
  s_waitcnt lgkmcnt(0)
  s_add_u32 s61, s60, 0x3c6ef372
  s_lshl_b32 s61, s61, 1
  s_or_b32 s61, s61, 1
  v_mov_b32 v59, s61
  v_bfe_u32 v16, v1, 3, 1
  v_lshlrev_b32 v16, 10, v16
  v_lshrrev_b32 v17, 4, v1
  v_lshl_add_u32 v16, v17, 7, v16
  v_and_b32 v17, 3, v1
  v_lshl_add_u32 v16, v17, 5, v16
  s_lshl_b32 s72, s56, 11
  s_add_u32 s72, s72, 0x1000
  s_mov_b32 s71, 0
L_qloop:
  buffer_load_dwordx4 v[24:27], v16, s[36:39], s72 offen offset:0 sc1
  buffer_load_dwordx4 v[28:31], v16, s[36:39], s72 offen offset:16 sc1
  buffer_load_dwordx4 v[32:35], v16, s[36:39], s72 offen offset:512 sc1
  buffer_load_dwordx4 v[36:39], v16, s[36:39], s72 offen offset:528 sc1
  s_waitcnt vmcnt(0)
  v_min3_u32 v54, v25, v27, v29
  v_max3_u32 v55, v25, v27, v29
  v_min3_u32 v54, v54, v31, v33
  v_max3_u32 v55, v55, v31, v33
  v_min3_u32 v54, v54, v35, v37
  v_max3_u32 v55, v55, v35, v37
  v_min_u32 v54, v54, v39
  v_max_u32 v55, v55, v39
  v_cmp_eq_u32 vcc, s61, v54
  v_cmp_eq_u32 s[78:79], s61, v55
  s_and_b64 vcc, vcc, s[78:79]
  s_cmp_eq_u64 vcc, -1
  s_cbranch_scc1 L_qok
  s_add_u32 s71, s71, 1
  s_cmp_lt_u32 s71, 262144
  s_cbranch_scc1 L_qloop
L_qok:
  v_mov_b32 v8, v24
  v_mov_b32 v9, v26
  v_mov_b32 v10, v28
  v_mov_b32 v11, v30
  v_mov_b32 v12, v32
  v_mov_b32 v13, v34
  v_mov_b32 v14, v36
  v_mov_b32 v15, v38
  v_lshlrev_b32 v16, 5, v1
  ds_write_b128 v16, v[8:11] offset:13312
  ds_write_b128 v16, v[12:15] offset:13328
  s_waitcnt lgkmcnt(0)
  s_barrier
  s_mov_b32 s62, s25
  s_add_u32 s63, s62, 4096
  s_add_u32 s76, s62, 8192
  s_add_u32 s77, s62, 12288
  buffer_load_dwordx4 a[64:67], v3, s[32:35], s62 offen offset:0 nt
  buffer_load_dwordx4 a[68:71], v3, s[32:35], s62 offen offset:256 nt
  buffer_load_dwordx4 a[72:75], v3, s[32:35], s62 offen offset:2048 nt
  buffer_load_dwordx4 a[76:79], v3, s[32:35], s62 offen offset:2304 nt
  buffer_load_dwordx4 a[80:83], v3, s[32:35], s63 offen offset:0 nt
  buffer_load_dwordx4 a[84:87], v3, s[32:35], s63 offen offset:256 nt
  buffer_load_dwordx4 a[88:91], v3, s[32:35], s63 offen offset:2048 nt
  buffer_load_dwordx4 a[92:95], v3, s[32:35], s63 offen offset:2304 nt
  buffer_load_dwordx4 a[96:99], v3, s[32:35], s76 offen offset:0 nt
  buffer_load_dwordx4 a[100:103], v3, s[32:35], s76 offen offset:256 nt
  buffer_load_dwordx4 a[104:107], v3, s[32:35], s76 offen offset:2048 nt
  buffer_load_dwordx4 a[108:111], v3, s[32:35], s76 offen offset:2304 nt
  buffer_load_dwordx4 a[112:115], v3, s[32:35], s77 offen offset:0 nt
  buffer_load_dwordx4 a[116:119], v3, s[32:35], s77 offen offset:256 nt
  buffer_load_dwordx4 a[120:123], v3, s[32:35], s77 offen offset:2048 nt
  buffer_load_dwordx4 a[124:127], v3, s[32:35], s77 offen offset:2304 nt
  s_mov_b32 s62, s98
  s_add_u32 s63, s62, 4096
  s_add_u32 s76, s62, 8192
  s_add_u32 s77, s62, 12288
  buffer_load_dwordx4 a[128:131], v2, s[28:31], s62 offen offset:0 nt
  buffer_load_dwordx4 a[132:135], v2, s[28:31], s62 offen offset:256 nt
  buffer_load_dwordx4 a[136:139], v2, s[28:31], s62 offen offset:2048 nt
  buffer_load_dwordx4 a[140:143], v2, s[28:31], s62 offen offset:2304 nt
  buffer_load_dwordx4 a[144:147], v2, s[28:31], s63 offen offset:0 nt
  buffer_load_dwordx4 a[148:151], v2, s[28:31], s63 offen offset:256 nt
  buffer_load_dwordx4 a[152:155], v2, s[28:31], s63 offen offset:2048 nt
  buffer_load_dwordx4 a[156:159], v2, s[28:31], s63 offen offset:2304 nt
  buffer_load_dwordx4 a[160:163], v2, s[28:31], s76 offen offset:0 nt
  buffer_load_dwordx4 a[164:167], v2, s[28:31], s76 offen offset:256 nt
  buffer_load_dwordx4 a[168:171], v2, s[28:31], s76 offen offset:2048 nt
  buffer_load_dwordx4 a[172:175], v2, s[28:31], s76 offen offset:2304 nt
  buffer_load_dwordx4 a[176:179], v2, s[28:31], s77 offen offset:0 nt
  buffer_load_dwordx4 a[180:183], v2, s[28:31], s77 offen offset:256 nt
  buffer_load_dwordx4 a[184:187], v2, s[28:31], s77 offen offset:2048 nt
  buffer_load_dwordx4 a[188:191], v2, s[28:31], s77 offen offset:2304 nt
L_init:
  v_mov_b32 v16, 0
  v_mov_b32 v17, 0
  v_mov_b32 v18, 0
  v_mov_b32 v19, 0
  v_mov_b32 v20, 0
  v_mov_b32 v21, 0
  v_mov_b32 v22, 0
  v_mov_b32 v23, 0
  v_mov_b32 v48, 0xff7fffff
  v_mul_f32 v49, s70, v48
  v_mov_b32 v50, 0
  s_waitcnt lgkmcnt(0)
  s_waitcnt vmcnt(32)
  v_mfma_f32_16x16x32_bf16 v[24:27], a[0:3], v[8:11], 0
  v_mfma_f32_16x16x32_bf16 v[28:31], a[8:11], v[8:11], 0
  v_mfma_f32_16x16x32_bf16 v[32:35], a[16:19], v[8:11], 0
  v_mfma_f32_16x16x32_bf16 v[36:39], a[24:27], v[8:11], 0
  v_mfma_f32_16x16x32_bf16 v[24:27], a[4:7], v[12:15], v[24:27]
  v_mfma_f32_16x16x32_bf16 v[28:31], a[12:15], v[12:15], v[28:31]
  v_mfma_f32_16x16x32_bf16 v[32:35], a[20:23], v[12:15], v[32:35]
  v_mfma_f32_16x16x32_bf16 v[36:39], a[28:31], v[12:15], v[36:39]
  s_nop 4
  v_mov_b32_dpp v40, v24 quad_perm:[0,0,0,0] row_mask:0xf bank_mask:0xf
  v_mov_b32_dpp v41, v28 quad_perm:[0,0,0,0] row_mask:0xf bank_mask:0xf
  v_mov_b32_dpp v42, v32 quad_perm:[0,0,0,0] row_mask:0xf bank_mask:0xf
  v_mov_b32_dpp v43, v36 quad_perm:[0,0,0,0] row_mask:0xf bank_mask:0xf
  v_add_f32_dpp v40, v25, v40 quad_perm:[1,1,1,1] row_mask:0xf bank_mask:0xf
  v_add_f32_dpp v41, v29, v41 quad_perm:[1,1,1,1] row_mask:0xf bank_mask:0xf
  v_add_f32_dpp v42, v33, v42 quad_perm:[1,1,1,1] row_mask:0xf bank_mask:0xf
  v_add_f32_dpp v43, v37, v43 quad_perm:[1,1,1,1] row_mask:0xf bank_mask:0xf
  v_add_f32_dpp v40, v26, v40 quad_perm:[2,2,2,2] row_mask:0xf bank_mask:0xf
  v_add_f32_dpp v41, v30, v41 quad_perm:[2,2,2,2] row_mask:0xf bank_mask:0xf
  v_add_f32_dpp v42, v34, v42 quad_perm:[2,2,2,2] row_mask:0xf bank_mask:0xf
  v_add_f32_dpp v43, v38, v43 quad_perm:[2,2,2,2] row_mask:0xf bank_mask:0xf
  v_add_f32_dpp v40, v27, v40 quad_perm:[3,3,3,3] row_mask:0xf bank_mask:0xf
  v_add_f32_dpp v41, v31, v41 quad_perm:[3,3,3,3] row_mask:0xf bank_mask:0xf
  v_add_f32_dpp v42, v35, v42 quad_perm:[3,3,3,3] row_mask:0xf bank_mask:0xf
  v_add_f32_dpp v43, v39, v43 quad_perm:[3,3,3,3] row_mask:0xf bank_mask:0xf
  v_mfma_f32_16x16x32_bf16 v[24:27], a[32:35], v[8:11], 0
  v_mfma_f32_16x16x32_bf16 v[28:31], a[40:43], v[8:11], 0
  v_mfma_f32_16x16x32_bf16 v[32:35], a[48:51], v[8:11], 0
  v_mfma_f32_16x16x32_bf16 v[36:39], a[56:59], v[8:11], 0
  v_mfma_f32_16x16x32_bf16 v[24:27], a[36:39], v[12:15], v[24:27]
  v_mfma_f32_16x16x32_bf16 v[28:31], a[44:47], v[12:15], v[28:31]
  v_mfma_f32_16x16x32_bf16 v[32:35], a[52:55], v[12:15], v[32:35]
  v_mfma_f32_16x16x32_bf16 v[36:39], a[60:63], v[12:15], v[36:39]
  s_nop 4
  v_mov_b32_dpp v44, v24 quad_perm:[0,0,0,0] row_mask:0xf bank_mask:0xf
  v_mov_b32_dpp v45, v28 quad_perm:[0,0,0,0] row_mask:0xf bank_mask:0xf
  v_mov_b32_dpp v46, v32 quad_perm:[0,0,0,0] row_mask:0xf bank_mask:0xf
  v_mov_b32_dpp v47, v36 quad_perm:[0,0,0,0] row_mask:0xf bank_mask:0xf
  v_add_f32_dpp v44, v25, v44 quad_perm:[1,1,1,1] row_mask:0xf bank_mask:0xf
  v_add_f32_dpp v45, v29, v45 quad_perm:[1,1,1,1] row_mask:0xf bank_mask:0xf
  v_add_f32_dpp v46, v33, v46 quad_perm:[1,1,1,1] row_mask:0xf bank_mask:0xf
  v_add_f32_dpp v47, v37, v47 quad_perm:[1,1,1,1] row_mask:0xf bank_mask:0xf
  v_add_f32_dpp v44, v26, v44 quad_perm:[2,2,2,2] row_mask:0xf bank_mask:0xf
  v_add_f32_dpp v45, v30, v45 quad_perm:[2,2,2,2] row_mask:0xf bank_mask:0xf
  v_add_f32_dpp v46, v34, v46 quad_perm:[2,2,2,2] row_mask:0xf bank_mask:0xf
  v_add_f32_dpp v47, v38, v47 quad_perm:[2,2,2,2] row_mask:0xf bank_mask:0xf
  v_add_f32_dpp v44, v27, v44 quad_perm:[3,3,3,3] row_mask:0xf bank_mask:0xf
  v_add_f32_dpp v45, v31, v45 quad_perm:[3,3,3,3] row_mask:0xf bank_mask:0xf
  v_add_f32_dpp v46, v35, v46 quad_perm:[3,3,3,3] row_mask:0xf bank_mask:0xf
  v_add_f32_dpp v47, v39, v47 quad_perm:[3,3,3,3] row_mask:0xf bank_mask:0xf
  v_cvt_pk_bf16_f32 v52, v40, v41
  v_cvt_pk_bf16_f32 v53, v42, v43
  v_cvt_pk_bf16_f32 v54, v44, v45
  v_cvt_pk_bf16_f32 v55, v46, v47
  v_lshlrev_b32 v40, 16, v52
  v_and_b32 v41, 0xffff0000, v52
  v_lshlrev_b32 v42, 16, v53
  v_and_b32 v43, 0xffff0000, v53
  v_lshlrev_b32 v44, 16, v54
  v_and_b32 v45, 0xffff0000, v54
  v_lshlrev_b32 v46, 16, v55
  v_and_b32 v47, 0xffff0000, v55
  v_max3_f32 v52, v40, v41, v42
  v_max3_f32 v53, v43, v44, v45
  v_max3_f32 v48, v46, v47, v48
  v_max3_f32 v48, v52, v53, v48
  v_mov_b32 v53, v48
  s_nop 1
  v_permlane16_swap_b32 v53, v48
  s_nop 1
  v_max_f32 v48, v48, v53
  v_mov_b32 v53, v48
  s_nop 1
  v_permlane32_swap_b32 v53, v48
  s_nop 1
  v_max_f32 v48, v48, v53
  v_mul_f32 v52, s70, v48
  v_sub_f32 v51, v49, v52
  v_mov_b32 v49, v52
  v_exp_f32 v51, v51
  v_fma_f32 v40, v40, s70, -v49
  v_fma_f32 v41, v41, s70, -v49
  v_fma_f32 v42, v42, s70, -v49
  v_fma_f32 v43, v43, s70, -v49
  v_fma_f32 v44, v44, s70, -v49
  v_fma_f32 v45, v45, s70, -v49
  v_fma_f32 v46, v46, s70, -v49
  v_fma_f32 v47, v47, s70, -v49
  v_exp_f32 v40, v40
  v_exp_f32 v41, v41
  v_exp_f32 v42, v42
  v_exp_f32 v43, v43
  v_exp_f32 v44, v44
  v_exp_f32 v45, v45
  v_exp_f32 v46, v46
  v_exp_f32 v47, v47
  s_mov_b64 vcc, s[66:67]
  v_cndmask_b32_dpp v54, v51, v51, vcc row_ror:8 row_mask:0xf bank_mask:0xf
  v_add_f32 v52, v40, v41
  v_add_f32 v53, v42, v43
  v_add_f32 v55, v44, v45
  v_fma_f32 v50, v50, v51, v52
  v_add_f32 v52, v46, v47
  v_add_f32 v53, v53, v55
  v_add_f32 v50, v50, v52
  v_add_f32 v50, v50, v53
  v_mul_f32 v16, v16, v54
  v_mul_f32 v17, v17, v54
  v_mul_f32 v18, v18, v54
  v_mul_f32 v19, v19, v54
  v_mul_f32 v20, v20, v54
  v_mul_f32 v21, v21, v54
  v_mul_f32 v22, v22, v54
  v_mul_f32 v23, v23, v54
  v_cvt_pk_bf16_f32 v40, v40, v40
  v_cvt_pk_bf16_f32 v41, v41, v41
  v_cvt_pk_bf16_f32 v42, v42, v42
  v_cvt_pk_bf16_f32 v43, v43, v43
  v_cvt_pk_bf16_f32 v44, v44, v44
  v_cvt_pk_bf16_f32 v45, v45, v45
  v_cvt_pk_bf16_f32 v46, v46, v46
  v_cvt_pk_bf16_f32 v47, v47, v47
  s_waitcnt vmcnt(16)
  v_and_b32 v24, v4, v40
  v_and_b32 v25, v5, v40
  v_and_b32 v26, v6, v40
  v_and_b32 v27, v7, v40
  v_and_b32 v28, v4, v41
  v_and_b32 v29, v5, v41
  v_and_b32 v30, v6, v41
  v_and_b32 v31, v7, v41
  v_and_b32 v32, v4, v42
  v_and_b32 v33, v5, v42
  v_and_b32 v34, v6, v42
  v_and_b32 v35, v7, v42
  v_and_b32 v36, v4, v43
  v_and_b32 v37, v5, v43
  v_and_b32 v38, v6, v43
  v_and_b32 v39, v7, v43
  s_nop 1
  v_mfma_f32_16x16x32_bf16 v[16:19], v[24:27], a[64:67], v[16:19]
  v_mfma_f32_16x16x32_bf16 v[20:23], v[24:27], a[68:71], v[20:23]
  v_mfma_f32_16x16x32_bf16 v[16:19], v[28:31], a[72:75], v[16:19]
  v_mfma_f32_16x16x32_bf16 v[20:23], v[28:31], a[76:79], v[20:23]
  v_mfma_f32_16x16x32_bf16 v[16:19], v[32:35], a[80:83], v[16:19]
  v_mfma_f32_16x16x32_bf16 v[20:23], v[32:35], a[84:87], v[20:23]
  v_mfma_f32_16x16x32_bf16 v[16:19], v[36:39], a[88:91], v[16:19]
  v_mfma_f32_16x16x32_bf16 v[20:23], v[36:39], a[92:95], v[20:23]
  v_and_b32 v24, v4, v44
  v_and_b32 v25, v5, v44
  v_and_b32 v26, v6, v44
  v_and_b32 v27, v7, v44
  v_and_b32 v28, v4, v45
  v_and_b32 v29, v5, v45
  v_and_b32 v30, v6, v45
  v_and_b32 v31, v7, v45
  v_and_b32 v32, v4, v46
  v_and_b32 v33, v5, v46
  v_and_b32 v34, v6, v46
  v_and_b32 v35, v7, v46
  v_and_b32 v36, v4, v47
  v_and_b32 v37, v5, v47
  v_and_b32 v38, v6, v47
  v_and_b32 v39, v7, v47
  s_nop 1
  v_mfma_f32_16x16x32_bf16 v[16:19], v[24:27], a[96:99], v[16:19]
  v_mfma_f32_16x16x32_bf16 v[20:23], v[24:27], a[100:103], v[20:23]
  v_mfma_f32_16x16x32_bf16 v[16:19], v[28:31], a[104:107], v[16:19]
  v_mfma_f32_16x16x32_bf16 v[20:23], v[28:31], a[108:111], v[20:23]
  v_mfma_f32_16x16x32_bf16 v[16:19], v[32:35], a[112:115], v[16:19]
  v_mfma_f32_16x16x32_bf16 v[20:23], v[32:35], a[116:119], v[20:23]
  v_mfma_f32_16x16x32_bf16 v[16:19], v[36:39], a[120:123], v[16:19]
  v_mfma_f32_16x16x32_bf16 v[20:23], v[36:39], a[124:127], v[20:23]
  s_mov_b32 s62, s98
  s_add_u32 s63, s62, 4096
  s_add_u32 s76, s62, 8192
  s_add_u32 s77, s62, 12288
  buffer_load_dwordx4 a[64:67], v3, s[32:35], s62 offen offset:0 nt
  buffer_load_dwordx4 a[68:71], v3, s[32:35], s62 offen offset:256 nt
  buffer_load_dwordx4 a[72:75], v3, s[32:35], s62 offen offset:2048 nt
  buffer_load_dwordx4 a[76:79], v3, s[32:35], s62 offen offset:2304 nt
  buffer_load_dwordx4 a[80:83], v3, s[32:35], s63 offen offset:0 nt
  buffer_load_dwordx4 a[84:87], v3, s[32:35], s63 offen offset:256 nt
  buffer_load_dwordx4 a[88:91], v3, s[32:35], s63 offen offset:2048 nt
  buffer_load_dwordx4 a[92:95], v3, s[32:35], s63 offen offset:2304 nt
  buffer_load_dwordx4 a[96:99], v3, s[32:35], s76 offen offset:0 nt
  buffer_load_dwordx4 a[100:103], v3, s[32:35], s76 offen offset:256 nt
  buffer_load_dwordx4 a[104:107], v3, s[32:35], s76 offen offset:2048 nt
  buffer_load_dwordx4 a[108:111], v3, s[32:35], s76 offen offset:2304 nt
  buffer_load_dwordx4 a[112:115], v3, s[32:35], s77 offen offset:0 nt
  buffer_load_dwordx4 a[116:119], v3, s[32:35], s77 offen offset:256 nt
  buffer_load_dwordx4 a[120:123], v3, s[32:35], s77 offen offset:2048 nt
  buffer_load_dwordx4 a[124:127], v3, s[32:35], s77 offen offset:2304 nt
  s_mov_b32 s23, 0
  s_cmp_eq_u32 s101, 0
  s_cbranch_scc1 L_tk0_done
  s_mov_b64 exec, 1
  ds_add_rtn_u32 v62, v61, v60 offset:15360
  s_mov_b64 exec, -1
  s_waitcnt lgkmcnt(0)
  v_readfirstlane_b32 s72, v62
  s_cmp_lt_u32 s72, s64
  s_cbranch_scc0 L_tk0_dyn
  s_lshl_b32 s25, s72, 14
  s_add_u32 s25, s25, s97
  s_mov_b32 s23, 1
  s_branch L_tk0_done
L_tk0_dyn:
  s_cmp_ge_u32 s3, 1
  s_cbranch_scc1 L_tk0_done
  s_mov_b32 s74, 1
  s_atomic_add s74, s[14:15], 0 glc
  s_waitcnt lgkmcnt(0)
  s_cmp_ge_u32 s74, s99
  s_cbranch_scc1 L_tk0_done
  s_add_u32 s73, s74, 928
  s_cmp_lt_u32 s74, 96
  s_cbranch_scc1 L_tk0_t
  s_sub_u32 s74, s74, 96
  s_lshr_b32 s73, s74, 1
  s_mul_i32 s73, s73, 29
  s_and_b32 s72, s74, 1
  s_add_u32 s73, s73, s72
  s_add_u32 s73, s73, 27
  s_cmp_lt_u32 s74, 16
  s_cbranch_scc1 L_tk0_t
  s_sub_u32 s74, s74, 16
  s_lshr_b32 s73, s74, 3
  s_mul_i32 s73, s73, 58
  s_and_b32 s74, s74, 7
  s_add_u32 s73, s73, s74
  s_add_u32 s73, s73, 253
L_tk0_t:
  s_lshl_b32 s25, s73, 14
  s_add_u32 s25, s25, s65
  s_mov_b32 s23, 1
L_tk0_done:
  s_waitcnt vmcnt(16)
  v_mfma_f32_16x16x32_bf16 v[24:27], a[128:131], v[8:11], 0
  v_mfma_f32_16x16x32_bf16 v[28:31], a[136:139], v[8:11], 0
  v_mfma_f32_16x16x32_bf16 v[32:35], a[144:147], v[8:11], 0
  v_mfma_f32_16x16x32_bf16 v[36:39], a[152:155], v[8:11], 0
  v_mfma_f32_16x16x32_bf16 v[24:27], a[132:135], v[12:15], v[24:27]
  v_mfma_f32_16x16x32_bf16 v[28:31], a[140:143], v[12:15], v[28:31]
  v_mfma_f32_16x16x32_bf16 v[32:35], a[148:151], v[12:15], v[32:35]
  v_mfma_f32_16x16x32_bf16 v[36:39], a[156:159], v[12:15], v[36:39]
  s_nop 4
  v_mov_b32_dpp v40, v24 quad_perm:[0,0,0,0] row_mask:0xf bank_mask:0xf
  v_mov_b32_dpp v41, v28 quad_perm:[0,0,0,0] row_mask:0xf bank_mask:0xf
  v_mov_b32_dpp v42, v32 quad_perm:[0,0,0,0] row_mask:0xf bank_mask:0xf
  v_mov_b32_dpp v43, v36 quad_perm:[0,0,0,0] row_mask:0xf bank_mask:0xf
  v_add_f32_dpp v40, v25, v40 quad_perm:[1,1,1,1] row_mask:0xf bank_mask:0xf
  v_add_f32_dpp v41, v29, v41 quad_perm:[1,1,1,1] row_mask:0xf bank_mask:0xf
  v_add_f32_dpp v42, v33, v42 quad_perm:[1,1,1,1] row_mask:0xf bank_mask:0xf
  v_add_f32_dpp v43, v37, v43 quad_perm:[1,1,1,1] row_mask:0xf bank_mask:0xf
  v_add_f32_dpp v40, v26, v40 quad_perm:[2,2,2,2] row_mask:0xf bank_mask:0xf
  v_add_f32_dpp v41, v30, v41 quad_perm:[2,2,2,2] row_mask:0xf bank_mask:0xf
  v_add_f32_dpp v42, v34, v42 quad_perm:[2,2,2,2] row_mask:0xf bank_mask:0xf
  v_add_f32_dpp v43, v38, v43 quad_perm:[2,2,2,2] row_mask:0xf bank_mask:0xf
  v_add_f32_dpp v40, v27, v40 quad_perm:[3,3,3,3] row_mask:0xf bank_mask:0xf
  v_add_f32_dpp v41, v31, v41 quad_perm:[3,3,3,3] row_mask:0xf bank_mask:0xf
  v_add_f32_dpp v42, v35, v42 quad_perm:[3,3,3,3] row_mask:0xf bank_mask:0xf
  v_add_f32_dpp v43, v39, v43 quad_perm:[3,3,3,3] row_mask:0xf bank_mask:0xf
  v_mfma_f32_16x16x32_bf16 v[24:27], a[160:163], v[8:11], 0
  v_mfma_f32_16x16x32_bf16 v[28:31], a[168:171], v[8:11], 0
  v_mfma_f32_16x16x32_bf16 v[32:35], a[176:179], v[8:11], 0
  v_mfma_f32_16x16x32_bf16 v[36:39], a[184:187], v[8:11], 0
  v_mfma_f32_16x16x32_bf16 v[24:27], a[164:167], v[12:15], v[24:27]
  v_mfma_f32_16x16x32_bf16 v[28:31], a[172:175], v[12:15], v[28:31]
  v_mfma_f32_16x16x32_bf16 v[32:35], a[180:183], v[12:15], v[32:35]
  v_mfma_f32_16x16x32_bf16 v[36:39], a[188:191], v[12:15], v[36:39]
  s_nop 4
  v_mov_b32_dpp v44, v24 quad_perm:[0,0,0,0] row_mask:0xf bank_mask:0xf
  v_mov_b32_dpp v45, v28 quad_perm:[0,0,0,0] row_mask:0xf bank_mask:0xf
  v_mov_b32_dpp v46, v32 quad_perm:[0,0,0,0] row_mask:0xf bank_mask:0xf
  v_mov_b32_dpp v47, v36 quad_perm:[0,0,0,0] row_mask:0xf bank_mask:0xf
  v_add_f32_dpp v44, v25, v44 quad_perm:[1,1,1,1] row_mask:0xf bank_mask:0xf
  v_add_f32_dpp v45, v29, v45 quad_perm:[1,1,1,1] row_mask:0xf bank_mask:0xf
  v_add_f32_dpp v46, v33, v46 quad_perm:[1,1,1,1] row_mask:0xf bank_mask:0xf
  v_add_f32_dpp v47, v37, v47 quad_perm:[1,1,1,1] row_mask:0xf bank_mask:0xf
  v_add_f32_dpp v44, v26, v44 quad_perm:[2,2,2,2] row_mask:0xf bank_mask:0xf
  v_add_f32_dpp v45, v30, v45 quad_perm:[2,2,2,2] row_mask:0xf bank_mask:0xf
  v_add_f32_dpp v46, v34, v46 quad_perm:[2,2,2,2] row_mask:0xf bank_mask:0xf
  v_add_f32_dpp v47, v38, v47 quad_perm:[2,2,2,2] row_mask:0xf bank_mask:0xf
  v_add_f32_dpp v44, v27, v44 quad_perm:[3,3,3,3] row_mask:0xf bank_mask:0xf
  v_add_f32_dpp v45, v31, v45 quad_perm:[3,3,3,3] row_mask:0xf bank_mask:0xf
  v_add_f32_dpp v46, v35, v46 quad_perm:[3,3,3,3] row_mask:0xf bank_mask:0xf
  v_add_f32_dpp v47, v39, v47 quad_perm:[3,3,3,3] row_mask:0xf bank_mask:0xf
  v_cvt_pk_bf16_f32 v52, v40, v41
  v_cvt_pk_bf16_f32 v53, v42, v43
  v_cvt_pk_bf16_f32 v54, v44, v45
  v_cvt_pk_bf16_f32 v55, v46, v47
  v_lshlrev_b32 v40, 16, v52
  v_and_b32 v41, 0xffff0000, v52
  v_lshlrev_b32 v42, 16, v53
  v_and_b32 v43, 0xffff0000, v53
  v_lshlrev_b32 v44, 16, v54
  v_and_b32 v45, 0xffff0000, v54
  v_lshlrev_b32 v46, 16, v55
  v_and_b32 v47, 0xffff0000, v55
  v_max3_f32 v52, v40, v41, v42
  v_max3_f32 v53, v43, v44, v45
  v_max3_f32 v48, v46, v47, v48
  v_max3_f32 v48, v52, v53, v48
  v_mov_b32 v53, v48
  s_nop 1
  v_permlane16_swap_b32 v53, v48
  s_nop 1
  v_max_f32 v48, v48, v53
  v_mov_b32 v53, v48
  s_nop 1
  v_permlane32_swap_b32 v53, v48
  s_nop 1
  v_max_f32 v48, v48, v53
  v_mul_f32 v52, s70, v48
  v_sub_f32 v51, v49, v52
  v_mov_b32 v49, v52
  v_exp_f32 v51, v51
  v_fma_f32 v40, v40, s70, -v49
  v_fma_f32 v41, v41, s70, -v49
  v_fma_f32 v42, v42, s70, -v49
  v_fma_f32 v43, v43, s70, -v49
  v_fma_f32 v44, v44, s70, -v49
  v_fma_f32 v45, v45, s70, -v49
  v_fma_f32 v46, v46, s70, -v49
  v_fma_f32 v47, v47, s70, -v49
  v_exp_f32 v40, v40
  v_exp_f32 v41, v41
  v_exp_f32 v42, v42
  v_exp_f32 v43, v43
  v_exp_f32 v44, v44
  v_exp_f32 v45, v45
  v_exp_f32 v46, v46
  v_exp_f32 v47, v47
  s_mov_b64 vcc, s[66:67]
  v_cndmask_b32_dpp v54, v51, v51, vcc row_ror:8 row_mask:0xf bank_mask:0xf
  v_add_f32 v52, v40, v41
  v_add_f32 v53, v42, v43
  v_add_f32 v55, v44, v45
  v_fma_f32 v50, v50, v51, v52
  v_add_f32 v52, v46, v47
  v_add_f32 v53, v53, v55
  v_add_f32 v50, v50, v52
  v_add_f32 v50, v50, v53
  v_mul_f32 v16, v16, v54
  v_mul_f32 v17, v17, v54
  v_mul_f32 v18, v18, v54
  v_mul_f32 v19, v19, v54
  v_mul_f32 v20, v20, v54
  v_mul_f32 v21, v21, v54
  v_mul_f32 v22, v22, v54
  v_mul_f32 v23, v23, v54
  v_cvt_pk_bf16_f32 v40, v40, v40
  v_cvt_pk_bf16_f32 v41, v41, v41
  v_cvt_pk_bf16_f32 v42, v42, v42
  v_cvt_pk_bf16_f32 v43, v43, v43
  v_cvt_pk_bf16_f32 v44, v44, v44
  v_cvt_pk_bf16_f32 v45, v45, v45
  v_cvt_pk_bf16_f32 v46, v46, v46
  v_cvt_pk_bf16_f32 v47, v47, v47
  s_branch L_mid
L_loop:
  s_mov_b32 s23, 0
  s_cmp_eq_u32 s101, 0
  s_cbranch_scc1 L_tk1_done
  s_mov_b64 exec, 1
  ds_add_rtn_u32 v62, v61, v60 offset:15360
  s_mov_b64 exec, -1
  s_waitcnt lgkmcnt(0)
  v_readfirstlane_b32 s72, v62
  s_cmp_lt_u32 s72, s64
  s_cbranch_scc0 L_tk1_dyn
  s_lshl_b32 s25, s72, 14
  s_add_u32 s25, s25, s97
  s_mov_b32 s23, 1
  s_branch L_tk1_done
L_tk1_dyn:
  s_cmp_ge_u32 s3, 1
  s_cbranch_scc1 L_tk1_done
  s_mov_b32 s74, 1
  s_atomic_add s74, s[14:15], 0 glc
  s_waitcnt lgkmcnt(0)
  s_cmp_ge_u32 s74, s99
  s_cbranch_scc1 L_tk1_done
  s_add_u32 s73, s74, 928
  s_cmp_lt_u32 s74, 96
  s_cbranch_scc1 L_tk1_t
  s_sub_u32 s74, s74, 96
  s_lshr_b32 s73, s74, 1
  s_mul_i32 s73, s73, 29
  s_and_b32 s72, s74, 1
  s_add_u32 s73, s73, s72
  s_add_u32 s73, s73, 27
  s_cmp_lt_u32 s74, 16
  s_cbranch_scc1 L_tk1_t
  s_sub_u32 s74, s74, 16
  s_lshr_b32 s73, s74, 3
  s_mul_i32 s73, s73, 58
  s_and_b32 s74, s74, 7
  s_add_u32 s73, s73, s74
  s_add_u32 s73, s73, 253
L_tk1_t:
  s_lshl_b32 s25, s73, 14
  s_add_u32 s25, s25, s65
  s_mov_b32 s23, 1
L_tk1_done:
  s_waitcnt vmcnt(16)
  v_mfma_f32_16x16x32_bf16 v[24:27], a[0:3], v[8:11], 0
  v_mfma_f32_16x16x32_bf16 v[28:31], a[8:11], v[8:11], 0
  v_mfma_f32_16x16x32_bf16 v[32:35], a[16:19], v[8:11], 0
  v_mfma_f32_16x16x32_bf16 v[36:39], a[24:27], v[8:11], 0
  v_mfma_f32_16x16x32_bf16 v[24:27], a[4:7], v[12:15], v[24:27]
  v_mfma_f32_16x16x32_bf16 v[28:31], a[12:15], v[12:15], v[28:31]
  v_mfma_f32_16x16x32_bf16 v[32:35], a[20:23], v[12:15], v[32:35]
  v_mfma_f32_16x16x32_bf16 v[36:39], a[28:31], v[12:15], v[36:39]
  s_nop 4
  v_mov_b32_dpp v40, v24 quad_perm:[0,0,0,0] row_mask:0xf bank_mask:0xf
  v_mov_b32_dpp v41, v28 quad_perm:[0,0,0,0] row_mask:0xf bank_mask:0xf
  v_mov_b32_dpp v42, v32 quad_perm:[0,0,0,0] row_mask:0xf bank_mask:0xf
  v_mov_b32_dpp v43, v36 quad_perm:[0,0,0,0] row_mask:0xf bank_mask:0xf
  v_add_f32_dpp v40, v25, v40 quad_perm:[1,1,1,1] row_mask:0xf bank_mask:0xf
  v_add_f32_dpp v41, v29, v41 quad_perm:[1,1,1,1] row_mask:0xf bank_mask:0xf
  v_add_f32_dpp v42, v33, v42 quad_perm:[1,1,1,1] row_mask:0xf bank_mask:0xf
  v_add_f32_dpp v43, v37, v43 quad_perm:[1,1,1,1] row_mask:0xf bank_mask:0xf
  v_add_f32_dpp v40, v26, v40 quad_perm:[2,2,2,2] row_mask:0xf bank_mask:0xf
  v_add_f32_dpp v41, v30, v41 quad_perm:[2,2,2,2] row_mask:0xf bank_mask:0xf
  v_add_f32_dpp v42, v34, v42 quad_perm:[2,2,2,2] row_mask:0xf bank_mask:0xf
  v_add_f32_dpp v43, v38, v43 quad_perm:[2,2,2,2] row_mask:0xf bank_mask:0xf
  v_add_f32_dpp v40, v27, v40 quad_perm:[3,3,3,3] row_mask:0xf bank_mask:0xf
  v_add_f32_dpp v41, v31, v41 quad_perm:[3,3,3,3] row_mask:0xf bank_mask:0xf
  v_add_f32_dpp v42, v35, v42 quad_perm:[3,3,3,3] row_mask:0xf bank_mask:0xf
  v_add_f32_dpp v43, v39, v43 quad_perm:[3,3,3,3] row_mask:0xf bank_mask:0xf
  v_mfma_f32_16x16x32_bf16 v[24:27], a[32:35], v[8:11], 0
  v_mfma_f32_16x16x32_bf16 v[28:31], a[40:43], v[8:11], 0
  v_mfma_f32_16x16x32_bf16 v[32:35], a[48:51], v[8:11], 0
  v_mfma_f32_16x16x32_bf16 v[36:39], a[56:59], v[8:11], 0
  v_mfma_f32_16x16x32_bf16 v[24:27], a[36:39], v[12:15], v[24:27]
  v_mfma_f32_16x16x32_bf16 v[28:31], a[44:47], v[12:15], v[28:31]
  v_mfma_f32_16x16x32_bf16 v[32:35], a[52:55], v[12:15], v[32:35]
  v_mfma_f32_16x16x32_bf16 v[36:39], a[60:63], v[12:15], v[36:39]
  s_nop 4
  v_mov_b32_dpp v44, v24 quad_perm:[0,0,0,0] row_mask:0xf bank_mask:0xf
  v_mov_b32_dpp v45, v28 quad_perm:[0,0,0,0] row_mask:0xf bank_mask:0xf
  v_mov_b32_dpp v46, v32 quad_perm:[0,0,0,0] row_mask:0xf bank_mask:0xf
  v_mov_b32_dpp v47, v36 quad_perm:[0,0,0,0] row_mask:0xf bank_mask:0xf
  v_add_f32_dpp v44, v25, v44 quad_perm:[1,1,1,1] row_mask:0xf bank_mask:0xf
  v_add_f32_dpp v45, v29, v45 quad_perm:[1,1,1,1] row_mask:0xf bank_mask:0xf
  v_add_f32_dpp v46, v33, v46 quad_perm:[1,1,1,1] row_mask:0xf bank_mask:0xf
  v_add_f32_dpp v47, v37, v47 quad_perm:[1,1,1,1] row_mask:0xf bank_mask:0xf
  v_add_f32_dpp v44, v26, v44 quad_perm:[2,2,2,2] row_mask:0xf bank_mask:0xf
  v_add_f32_dpp v45, v30, v45 quad_perm:[2,2,2,2] row_mask:0xf bank_mask:0xf
  v_add_f32_dpp v46, v34, v46 quad_perm:[2,2,2,2] row_mask:0xf bank_mask:0xf
  v_add_f32_dpp v47, v38, v47 quad_perm:[2,2,2,2] row_mask:0xf bank_mask:0xf
  v_add_f32_dpp v44, v27, v44 quad_perm:[3,3,3,3] row_mask:0xf bank_mask:0xf
  v_add_f32_dpp v45, v31, v45 quad_perm:[3,3,3,3] row_mask:0xf bank_mask:0xf
  v_add_f32_dpp v46, v35, v46 quad_perm:[3,3,3,3] row_mask:0xf bank_mask:0xf
  v_add_f32_dpp v47, v39, v47 quad_perm:[3,3,3,3] row_mask:0xf bank_mask:0xf
  v_cvt_pk_bf16_f32 v52, v40, v41
  v_cvt_pk_bf16_f32 v53, v42, v43
  v_cvt_pk_bf16_f32 v54, v44, v45
  v_cvt_pk_bf16_f32 v55, v46, v47
  v_lshlrev_b32 v40, 16, v52
  v_and_b32 v41, 0xffff0000, v52
  v_lshlrev_b32 v42, 16, v53
  v_and_b32 v43, 0xffff0000, v53
  v_lshlrev_b32 v44, 16, v54
  v_and_b32 v45, 0xffff0000, v54
  v_lshlrev_b32 v46, 16, v55
  v_and_b32 v47, 0xffff0000, v55
  v_max3_f32 v52, v40, v41, v42
  v_max3_f32 v53, v43, v44, v45
  v_max3_f32 v48, v46, v47, v48
  v_max3_f32 v48, v52, v53, v48
  v_mov_b32 v53, v48
  s_nop 1
  v_permlane16_swap_b32 v53, v48
  s_nop 1
  v_max_f32 v48, v48, v53
  v_mov_b32 v53, v48
  s_nop 1
  v_permlane32_swap_b32 v53, v48
  s_nop 1
  v_max_f32 v48, v48, v53
  v_mul_f32 v52, s70, v48
  v_sub_f32 v51, v49, v52
  v_mov_b32 v49, v52
  v_exp_f32 v51, v51
  v_fma_f32 v40, v40, s70, -v49
  v_fma_f32 v41, v41, s70, -v49
  v_fma_f32 v42, v42, s70, -v49
  v_fma_f32 v43, v43, s70, -v49
  v_fma_f32 v44, v44, s70, -v49
  v_fma_f32 v45, v45, s70, -v49
  v_fma_f32 v46, v46, s70, -v49
  v_fma_f32 v47, v47, s70, -v49
  v_exp_f32 v40, v40
  v_exp_f32 v41, v41
  v_exp_f32 v42, v42
  v_exp_f32 v43, v43
  v_exp_f32 v44, v44
  v_exp_f32 v45, v45
  v_exp_f32 v46, v46
  v_exp_f32 v47, v47
  s_mov_b64 vcc, s[66:67]
  v_cndmask_b32_dpp v54, v51, v51, vcc row_ror:8 row_mask:0xf bank_mask:0xf
  v_add_f32 v52, v40, v41
  v_add_f32 v53, v42, v43
  v_add_f32 v55, v44, v45
  v_fma_f32 v50, v50, v51, v52
  v_add_f32 v52, v46, v47
  v_add_f32 v53, v53, v55
  v_add_f32 v50, v50, v52
  v_add_f32 v50, v50, v53
  v_mul_f32 v16, v16, v54
  v_mul_f32 v17, v17, v54
  v_mul_f32 v18, v18, v54
  v_mul_f32 v19, v19, v54
  v_mul_f32 v20, v20, v54
  v_mul_f32 v21, v21, v54
  v_mul_f32 v22, v22, v54
  v_mul_f32 v23, v23, v54
  v_cvt_pk_bf16_f32 v40, v40, v40
  v_cvt_pk_bf16_f32 v41, v41, v41
  v_cvt_pk_bf16_f32 v42, v42, v42
  v_cvt_pk_bf16_f32 v43, v43, v43
  v_cvt_pk_bf16_f32 v44, v44, v44
  v_cvt_pk_bf16_f32 v45, v45, v45
  v_cvt_pk_bf16_f32 v46, v46, v46
  v_cvt_pk_bf16_f32 v47, v47, v47
L_mid:
  s_cmp_eq_u32 s23, 0
  s_cbranch_scc1 L_last
  s_mov_b32 s62, s25
  s_add_u32 s63, s62, 4096
  s_add_u32 s76, s62, 8192
  s_add_u32 s77, s62, 12288
  buffer_load_dwordx4 a[0:3], v2, s[28:31], s62 offen offset:0 nt
  buffer_load_dwordx4 a[4:7], v2, s[28:31], s62 offen offset:256 nt
  buffer_load_dwordx4 a[8:11], v2, s[28:31], s62 offen offset:2048 nt
  buffer_load_dwordx4 a[12:15], v2, s[28:31], s62 offen offset:2304 nt
  buffer_load_dwordx4 a[16:19], v2, s[28:31], s63 offen offset:0 nt
  buffer_load_dwordx4 a[20:23], v2, s[28:31], s63 offen offset:256 nt
  buffer_load_dwordx4 a[24:27], v2, s[28:31], s63 offen offset:2048 nt
  buffer_load_dwordx4 a[28:31], v2, s[28:31], s63 offen offset:2304 nt
  buffer_load_dwordx4 a[32:35], v2, s[28:31], s76 offen offset:0 nt
  buffer_load_dwordx4 a[36:39], v2, s[28:31], s76 offen offset:256 nt
  buffer_load_dwordx4 a[40:43], v2, s[28:31], s76 offen offset:2048 nt
  buffer_load_dwordx4 a[44:47], v2, s[28:31], s76 offen offset:2304 nt
  buffer_load_dwordx4 a[48:51], v2, s[28:31], s77 offen offset:0 nt
  buffer_load_dwordx4 a[52:55], v2, s[28:31], s77 offen offset:256 nt
  buffer_load_dwordx4 a[56:59], v2, s[28:31], s77 offen offset:2048 nt
  buffer_load_dwordx4 a[60:63], v2, s[28:31], s77 offen offset:2304 nt
  s_waitcnt vmcnt(16)
  v_and_b32 v24, v4, v40
  v_and_b32 v25, v5, v40
  v_and_b32 v26, v6, v40
  v_and_b32 v27, v7, v40
  v_and_b32 v28, v4, v41
  v_and_b32 v29, v5, v41
  v_and_b32 v30, v6, v41
  v_and_b32 v31, v7, v41
  v_and_b32 v32, v4, v42
  v_and_b32 v33, v5, v42
  v_and_b32 v34, v6, v42
  v_and_b32 v35, v7, v42
  v_and_b32 v36, v4, v43
  v_and_b32 v37, v5, v43
  v_and_b32 v38, v6, v43
  v_and_b32 v39, v7, v43
  s_nop 1
  v_mfma_f32_16x16x32_bf16 v[16:19], v[24:27], a[64:67], v[16:19]
  v_mfma_f32_16x16x32_bf16 v[20:23], v[24:27], a[68:71], v[20:23]
  v_mfma_f32_16x16x32_bf16 v[16:19], v[28:31], a[72:75], v[16:19]
  v_mfma_f32_16x16x32_bf16 v[20:23], v[28:31], a[76:79], v[20:23]
  v_mfma_f32_16x16x32_bf16 v[16:19], v[32:35], a[80:83], v[16:19]
  v_mfma_f32_16x16x32_bf16 v[20:23], v[32:35], a[84:87], v[20:23]
  v_mfma_f32_16x16x32_bf16 v[16:19], v[36:39], a[88:91], v[16:19]
  v_mfma_f32_16x16x32_bf16 v[20:23], v[36:39], a[92:95], v[20:23]
  v_and_b32 v24, v4, v44
  v_and_b32 v25, v5, v44
  v_and_b32 v26, v6, v44
  v_and_b32 v27, v7, v44
  v_and_b32 v28, v4, v45
  v_and_b32 v29, v5, v45
  v_and_b32 v30, v6, v45
  v_and_b32 v31, v7, v45
  v_and_b32 v32, v4, v46
  v_and_b32 v33, v5, v46
  v_and_b32 v34, v6, v46
  v_and_b32 v35, v7, v46
  v_and_b32 v36, v4, v47
  v_and_b32 v37, v5, v47
  v_and_b32 v38, v6, v47
  v_and_b32 v39, v7, v47
  s_nop 1
  v_mfma_f32_16x16x32_bf16 v[16:19], v[24:27], a[96:99], v[16:19]
  v_mfma_f32_16x16x32_bf16 v[20:23], v[24:27], a[100:103], v[20:23]
  v_mfma_f32_16x16x32_bf16 v[16:19], v[28:31], a[104:107], v[16:19]
  v_mfma_f32_16x16x32_bf16 v[20:23], v[28:31], a[108:111], v[20:23]
  v_mfma_f32_16x16x32_bf16 v[16:19], v[32:35], a[112:115], v[16:19]
  v_mfma_f32_16x16x32_bf16 v[20:23], v[32:35], a[116:119], v[20:23]
  v_mfma_f32_16x16x32_bf16 v[16:19], v[36:39], a[120:123], v[16:19]
  v_mfma_f32_16x16x32_bf16 v[20:23], v[36:39], a[124:127], v[20:23]
  s_mov_b32 s62, s25
  s_add_u32 s63, s62, 4096
  s_add_u32 s76, s62, 8192
  s_add_u32 s77, s62, 12288
  buffer_load_dwordx4 a[64:67], v3, s[32:35], s62 offen offset:0 nt
  buffer_load_dwordx4 a[68:71], v3, s[32:35], s62 offen offset:256 nt
  buffer_load_dwordx4 a[72:75], v3, s[32:35], s62 offen offset:2048 nt
  buffer_load_dwordx4 a[76:79], v3, s[32:35], s62 offen offset:2304 nt
  buffer_load_dwordx4 a[80:83], v3, s[32:35], s63 offen offset:0 nt
  buffer_load_dwordx4 a[84:87], v3, s[32:35], s63 offen offset:256 nt
  buffer_load_dwordx4 a[88:91], v3, s[32:35], s63 offen offset:2048 nt
  buffer_load_dwordx4 a[92:95], v3, s[32:35], s63 offen offset:2304 nt
  buffer_load_dwordx4 a[96:99], v3, s[32:35], s76 offen offset:0 nt
  buffer_load_dwordx4 a[100:103], v3, s[32:35], s76 offen offset:256 nt
  buffer_load_dwordx4 a[104:107], v3, s[32:35], s76 offen offset:2048 nt
  buffer_load_dwordx4 a[108:111], v3, s[32:35], s76 offen offset:2304 nt
  buffer_load_dwordx4 a[112:115], v3, s[32:35], s77 offen offset:0 nt
  buffer_load_dwordx4 a[116:119], v3, s[32:35], s77 offen offset:256 nt
  buffer_load_dwordx4 a[120:123], v3, s[32:35], s77 offen offset:2048 nt
  buffer_load_dwordx4 a[124:127], v3, s[32:35], s77 offen offset:2304 nt
  s_branch L_loop
L_last:
  s_cmp_lg_u32 s3, 0
  s_cbranch_scc1 L_last1
  ds_write_b32 v61, v60 offset:15364
  v_lshrrev_b32 v52, 4, v1
  v_and_b32 v53, 15, v1
  v_mul_u32_u24 v52, 3584, v52
  v_lshl_add_u32 v52, v53, 4, v52
  s_mul_i32 s72, s24, 14336
  s_lshl_b32 s73, s3, 8
  s_add_u32 s72, s72, s73
  buffer_load_dwordx4 a[128:131], v52, s[44:47], s72 offen offset:0 nt
  buffer_load_dwordx4 a[132:135], v52, s[44:47], s72 offen offset:896 nt
  buffer_load_dwordx4 a[136:139], v52, s[44:47], s72 offen offset:1792 nt
  buffer_load_dwordx4 a[140:143], v52, s[44:47], s72 offen offset:2688 nt
  s_waitcnt vmcnt(4)
  v_and_b32 v24, v4, v40
  v_and_b32 v25, v5, v40
  v_and_b32 v26, v6, v40
  v_and_b32 v27, v7, v40
  v_and_b32 v28, v4, v41
  v_and_b32 v29, v5, v41
  v_and_b32 v30, v6, v41
  v_and_b32 v31, v7, v41
  v_and_b32 v32, v4, v42
  v_and_b32 v33, v5, v42
  v_and_b32 v34, v6, v42
  v_and_b32 v35, v7, v42
  v_and_b32 v36, v4, v43
  v_and_b32 v37, v5, v43
  v_and_b32 v38, v6, v43
  v_and_b32 v39, v7, v43
  s_nop 1
  v_mfma_f32_16x16x32_bf16 v[16:19], v[24:27], a[64:67], v[16:19]
  v_mfma_f32_16x16x32_bf16 v[20:23], v[24:27], a[68:71], v[20:23]
  v_mfma_f32_16x16x32_bf16 v[16:19], v[28:31], a[72:75], v[16:19]
  v_mfma_f32_16x16x32_bf16 v[20:23], v[28:31], a[76:79], v[20:23]
  v_mfma_f32_16x16x32_bf16 v[16:19], v[32:35], a[80:83], v[16:19]
  v_mfma_f32_16x16x32_bf16 v[20:23], v[32:35], a[84:87], v[20:23]
  v_mfma_f32_16x16x32_bf16 v[16:19], v[36:39], a[88:91], v[16:19]
  v_mfma_f32_16x16x32_bf16 v[20:23], v[36:39], a[92:95], v[20:23]
  v_and_b32 v24, v4, v44
  v_and_b32 v25, v5, v44
  v_and_b32 v26, v6, v44
  v_and_b32 v27, v7, v44
  v_and_b32 v28, v4, v45
  v_and_b32 v29, v5, v45
  v_and_b32 v30, v6, v45
  v_and_b32 v31, v7, v45
  v_and_b32 v32, v4, v46
  v_and_b32 v33, v5, v46
  v_and_b32 v34, v6, v46
  v_and_b32 v35, v7, v46
  v_and_b32 v36, v4, v47
  v_and_b32 v37, v5, v47
  v_and_b32 v38, v6, v47
  v_and_b32 v39, v7, v47
  s_nop 1
  v_mfma_f32_16x16x32_bf16 v[16:19], v[24:27], a[96:99], v[16:19]
  v_mfma_f32_16x16x32_bf16 v[20:23], v[24:27], a[100:103], v[20:23]
  v_mfma_f32_16x16x32_bf16 v[16:19], v[28:31], a[104:107], v[16:19]
  v_mfma_f32_16x16x32_bf16 v[20:23], v[28:31], a[108:111], v[20:23]
  v_mfma_f32_16x16x32_bf16 v[16:19], v[32:35], a[112:115], v[16:19]
  v_mfma_f32_16x16x32_bf16 v[20:23], v[32:35], a[116:119], v[20:23]
  v_mfma_f32_16x16x32_bf16 v[16:19], v[36:39], a[120:123], v[16:19]
  v_mfma_f32_16x16x32_bf16 v[20:23], v[36:39], a[124:127], v[20:23]
  s_branch L_done
L_last1:
  s_waitcnt vmcnt(0)
  v_and_b32 v24, v4, v40
  v_and_b32 v25, v5, v40
  v_and_b32 v26, v6, v40
  v_and_b32 v27, v7, v40
  v_and_b32 v28, v4, v41
  v_and_b32 v29, v5, v41
  v_and_b32 v30, v6, v41
  v_and_b32 v31, v7, v41
  v_and_b32 v32, v4, v42
  v_and_b32 v33, v5, v42
  v_and_b32 v34, v6, v42
  v_and_b32 v35, v7, v42
  v_and_b32 v36, v4, v43
  v_and_b32 v37, v5, v43
  v_and_b32 v38, v6, v43
  v_and_b32 v39, v7, v43
  s_nop 1
  v_mfma_f32_16x16x32_bf16 v[16:19], v[24:27], a[64:67], v[16:19]
  v_mfma_f32_16x16x32_bf16 v[20:23], v[24:27], a[68:71], v[20:23]
  v_mfma_f32_16x16x32_bf16 v[16:19], v[28:31], a[72:75], v[16:19]
  v_mfma_f32_16x16x32_bf16 v[20:23], v[28:31], a[76:79], v[20:23]
  v_mfma_f32_16x16x32_bf16 v[16:19], v[32:35], a[80:83], v[16:19]
  v_mfma_f32_16x16x32_bf16 v[20:23], v[32:35], a[84:87], v[20:23]
  v_mfma_f32_16x16x32_bf16 v[16:19], v[36:39], a[88:91], v[16:19]
  v_mfma_f32_16x16x32_bf16 v[20:23], v[36:39], a[92:95], v[20:23]
  v_and_b32 v24, v4, v44
  v_and_b32 v25, v5, v44
  v_and_b32 v26, v6, v44
  v_and_b32 v27, v7, v44
  v_and_b32 v28, v4, v45
  v_and_b32 v29, v5, v45
  v_and_b32 v30, v6, v45
  v_and_b32 v31, v7, v45
  v_and_b32 v32, v4, v46
  v_and_b32 v33, v5, v46
  v_and_b32 v34, v6, v46
  v_and_b32 v35, v7, v46
  v_and_b32 v36, v4, v47
  v_and_b32 v37, v5, v47
  v_and_b32 v38, v6, v47
  v_and_b32 v39, v7, v47
  s_nop 1
  v_mfma_f32_16x16x32_bf16 v[16:19], v[24:27], a[96:99], v[16:19]
  v_mfma_f32_16x16x32_bf16 v[20:23], v[24:27], a[100:103], v[20:23]
  v_mfma_f32_16x16x32_bf16 v[16:19], v[28:31], a[104:107], v[16:19]
  v_mfma_f32_16x16x32_bf16 v[20:23], v[28:31], a[108:111], v[20:23]
  v_mfma_f32_16x16x32_bf16 v[16:19], v[32:35], a[112:115], v[16:19]
  v_mfma_f32_16x16x32_bf16 v[20:23], v[32:35], a[116:119], v[20:23]
  v_mfma_f32_16x16x32_bf16 v[16:19], v[36:39], a[120:123], v[16:19]
  v_mfma_f32_16x16x32_bf16 v[20:23], v[36:39], a[124:127], v[20:23]
  s_mov_b32 s71, 0
L_wowait:
  ds_read_b32 v52, v61 offset:15364
  s_waitcnt lgkmcnt(0)
  v_readfirstlane_b32 s72, v52
  s_cmp_lg_u32 s72, 0
  s_cbranch_scc1 L_wogo
  s_sleep 4
  s_add_u32 s71, s71, 1
  s_cmp_lt_u32 s71, 1048576
  s_cbranch_scc1 L_wowait
L_wogo:
  v_lshrrev_b32 v52, 4, v1
  v_and_b32 v53, 15, v1
  v_mul_u32_u24 v52, 3584, v52
  v_lshl_add_u32 v52, v53, 4, v52
  s_mul_i32 s72, s24, 14336
  s_lshl_b32 s73, s3, 8
  s_add_u32 s72, s72, s73
  buffer_load_dwordx4 a[128:131], v52, s[44:47], s72 offen offset:0 nt
  buffer_load_dwordx4 a[132:135], v52, s[44:47], s72 offen offset:896 nt
  buffer_load_dwordx4 a[136:139], v52, s[44:47], s72 offen offset:1792 nt
  buffer_load_dwordx4 a[140:143], v52, s[44:47], s72 offen offset:2688 nt
L_done:
  v_mov_b32 v52, v50
  s_nop 1
  v_permlane16_swap_b32 v52, v50
  s_nop 1
  v_add_f32 v50, v50, v52
  v_mov_b32 v52, v50
  s_nop 1
  v_permlane32_swap_b32 v52, v50
  s_nop 1
  v_add_f32 v50, v50, v52
  v_lshrrev_b32 v52, 5, v1
  v_lshlrev_b32 v52, 10, v52
  v_and_b32 v53, 15, v1
  v_lshl_add_u32 v52, v53, 5, v52
  v_bfe_u32 v53, v1, 4, 1
  v_lshl_add_u32 v52, v53, 4, v52
  s_lshl_b32 s72, s3, 11
  v_add_u32 v52, s72, v52
  ds_write_b128 v52, v[16:19] offset:32768
  ds_write_b128 v52, v[20:23] offset:33280
  v_mov_b32 v54, v48
  v_mov_b32 v55, v50
  s_lshl_b32 s72, s3, 4
  v_add_u32 v53, s72, v1
  s_mov_b32 exec_lo, 0x101
  s_mov_b32 exec_hi, 0
  ds_write_b64 v53, v[54:55] offset:40960
  s_mov_b64 exec, -1
  s_lshr_b32 s72, s3, 1
  s_lshl_b32 s73, s72, 3
  v_mov_b32 v52, s73
  v_lshrrev_b32 v53, 1, v57
  v_mov_b32 v25, v59
  v_mov_b32 v27, v59
  v_mov_b32 v29, v59
  v_mov_b32 v31, v59
  s_lshl_b32 s74, s56, 17
  s_lshl_b32 s73, s57, 7
  s_add_u32 s74, s74, s73
  s_add_u32 s74, s74, 0x100000
  s_mov_b32 s4, 0x80808080
  s_mov_b32 s5, 0x80808080
  s_waitcnt lgkmcnt(0)
  s_barrier
  ds_read_b64 v[8:9], v52 offset:40960
  ds_read_b64 v[10:11], v52 offset:40976
  ds_read_b64 v[12:13], v52 offset:40992
  ds_read_b64 v[14:15], v52 offset:41008
  ds_read_b64 v[16:17], v53 offset:32768
  ds_read_b64 v[18:19], v53 offset:34816
  ds_read_b64 v[20:21], v53 offset:36864
  ds_read_b64 v[22:23], v53 offset:38912
  s_waitcnt lgkmcnt(4)
  v_max3_f32 v24, v8, v10, v12
  v_max_f32 v24, v24, v14
  v_sub_f32 v8, v8, v24
  v_mul_f32 v8, s70, v8
  v_sub_f32 v10, v10, v24
  v_mul_f32 v10, s70, v10
  v_sub_f32 v12, v12, v24
  v_mul_f32 v12, s70, v12
  v_sub_f32 v14, v14, v24
  v_mul_f32 v14, s70, v14
  v_exp_f32 v8, v8
  v_exp_f32 v10, v10
  v_exp_f32 v12, v12
  v_exp_f32 v14, v14
  s_waitcnt lgkmcnt(0)
  v_mul_f32 v28, v8, v16
  v_mul_f32 v30, v8, v17
  v_mul_f32 v26, v8, v9
  v_fmac_f32 v28, v10, v18
  v_fmac_f32 v30, v10, v19
  v_fmac_f32 v26, v10, v11
  v_fmac_f32 v28, v12, v20
  v_fmac_f32 v30, v12, v21
  v_fmac_f32 v26, v12, v13
  v_fmac_f32 v28, v14, v22
  v_fmac_f32 v30, v14, v23
  v_fmac_f32 v26, v14, v15
  v_rcp_f32 v25, v26
  v_log_f32 v27, v26
  s_nop 0
  v_mul_f32 v32, v28, v25
  v_mul_f32 v33, v30, v25
  v_fma_f32 v34, -v32, v26, v28
  v_fma_f32 v35, -v33, v26, v30
  v_fma_f32 v28, v34, v25, v32
  v_fma_f32 v30, v35, v25, v33
  v_fma_f32 v27, v24, s70, v27
  v_cndmask_b32 v29, v29, v30, s[4:5]
  v_cndmask_b32 v30, v30, v27, s[4:5]
  buffer_store_dwordx4 v[28:31], v58, s[36:39], s74 offen sc1
  v_mov_b32 v46, 0
  v_mov_b32 v47, 0
  s_cmp_eq_u32 s3, 0
  s_cbranch_scc1 L_h1
  s_cmp_ge_u32 s2, 28
  s_cbranch_scc1 L_h1wait
  s_cmp_eq_u32 s3, 1
  s_cbranch_scc1 L_ffgo
  s_lshl_b32 s72, s2, 15
  s_lshl_b32 s73, s3, 14
  s_add_u32 s72, s72, s73
  s_add_u32 s72, s72, 0x2f8000
  buffer_load_dwordx4 a[0:3], v63, s[36:39], s72 offen offset:0 sc1
  buffer_load_dwordx4 a[4:7], v63, s[36:39], s72 offen offset:1024 sc1
  buffer_load_dwordx4 a[8:11], v63, s[36:39], s72 offen offset:2048 sc1
  buffer_load_dwordx4 a[12:15], v63, s[36:39], s72 offen offset:3072 sc1
  s_add_u32 s72, s72, 4096
  buffer_load_dwordx4 a[16:19], v63, s[36:39], s72 offen offset:0 sc1
  buffer_load_dwordx4 a[20:23], v63, s[36:39], s72 offen offset:1024 sc1
  buffer_load_dwordx4 a[24:27], v63, s[36:39], s72 offen offset:2048 sc1
  buffer_load_dwordx4 a[28:31], v63, s[36:39], s72 offen offset:3072 sc1
  s_add_u32 s72, s72, 4096
  buffer_load_dwordx4 a[32:35], v63, s[36:39], s72 offen offset:0 sc1
  buffer_load_dwordx4 a[36:39], v63, s[36:39], s72 offen offset:1024 sc1
  buffer_load_dwordx4 a[40:43], v63, s[36:39], s72 offen offset:2048 sc1
  buffer_load_dwordx4 a[44:47], v63, s[36:39], s72 offen offset:3072 sc1
  s_add_u32 s72, s72, 4096
  buffer_load_dwordx4 a[48:51], v63, s[36:39], s72 offen offset:0 sc1
  buffer_load_dwordx4 a[52:55], v63, s[36:39], s72 offen offset:1024 sc1
  buffer_load_dwordx4 a[56:59], v63, s[36:39], s72 offen offset:2048 sc1
  buffer_load_dwordx4 a[60:63], v63, s[36:39], s72 offen offset:3072 sc1
  s_branch L_h1wait
L_ffgo:
  s_lshl_b32 s72, s2, 12
  s_add_u32 s72, s72, 0x10000
  v_mov_b32 v21, v59
  v_mov_b32 v23, v59
  v_mov_b32 v20, 0
  v_mov_b32 v22, 0
  s_mov_b32 s71, 0
L_ffloop:
  buffer_load_dwordx4 v[8:11], v63, s[36:39], s72 offen offset:0 sc1
  buffer_load_dwordx4 v[12:15], v63, s[36:39], s72 offen offset:1024 sc1
  buffer_load_dwordx4 v[16:19], v63, s[36:39], s72 offen offset:2048 sc1
  s_mov_b32 exec_hi, 0
  buffer_load_dwordx4 v[20:23], v63, s[36:39], s72 offen offset:3072 sc1
  s_mov_b64 exec, -1
  s_waitcnt vmcnt(0)
  v_min3_u32 v54, v9, v11, v13
  v_max3_u32 v55, v9, v11, v13
  v_min3_u32 v54, v54, v15, v17
  v_max3_u32 v55, v55, v15, v17
  v_min3_u32 v54, v54, v19, v21
  v_max3_u32 v55, v55, v19, v21
  v_min_u32 v54, v54, v23
  v_max_u32 v55, v55, v23
  v_cmp_eq_u32 vcc, s61, v54
  v_cmp_eq_u32 s[78:79], s61, v55
  s_and_b64 vcc, vcc, s[78:79]
  s_cmp_eq_u64 vcc, -1
  s_cbranch_scc1 L_ffok
  s_add_u32 s71, s71, 1
  s_cmp_lt_u32 s71, 262144
  s_cbranch_scc1 L_ffloop
L_ffok:
  v_add_f32 v8, v8, v12
  v_add_f32 v10, v10, v14
  v_add_f32 v16, v16, v20
  v_add_f32 v18, v18, v22
  v_add_f32 v46, v8, v16
  v_add_f32 v47, v10, v18
  s_branch L_h1wait
L_h1:
  v_and_b32 v33, 15, v1
  v_lshlrev_b32 v33, 7, v33
  v_lshrrev_b32 v34, 4, v1
  v_lshl_add_u32 v34, v34, 5, v33
  s_lshl_b32 s75, s24, 12
  s_add_u32 s75, s75, 0x100000
  s_mov_b32 s4, 0
  s_mov_b32 s5, 0xffff0000
  v_and_b32 v35, 7, v1
  v_lshlrev_b32 v35, 2, v35
  s_lshl_b32 s74, s2, 5
  buffer_load_dword v57, v35, s[40:43], s74 offen
  s_mov_b32 s71, 0
L_h1loop:
  buffer_load_dwordx4 v[16:19], v34, s[36:39], s75 offen sc1
  buffer_load_dwordx4 v[20:23], v34, s[36:39], s75 offen offset:16 sc1
  buffer_load_dwordx4 v[24:27], v34, s[36:39], s75 offen offset:2048 sc1
  buffer_load_dwordx4 v[28:31], v34, s[36:39], s75 offen offset:2064 sc1
  buffer_load_dwordx2 v[36:37], v33, s[36:39], s75 offen offset:120 sc1
  buffer_load_dwordx2 v[38:39], v33, s[36:39], s75 offen offset:2168 sc1
  s_waitcnt vmcnt(0)
  v_cndmask_b32 v40, v21, v59, s[4:5]
  v_cndmask_b32 v41, v29, v59, s[4:5]
  v_min3_u32 v54, v17, v19, v40
  v_max3_u32 v55, v17, v19, v40
  v_min3_u32 v54, v54, v23, v25
  v_max3_u32 v55, v55, v23, v25
  v_min3_u32 v54, v54, v27, v41
  v_max3_u32 v55, v55, v27, v41
  v_min3_u32 v54, v54, v31, v37
  v_max3_u32 v55, v55, v31, v37
  v_min_u32 v54, v54, v39
  v_max_u32 v55, v55, v39
  v_cmp_eq_u32 vcc, s61, v54
  v_cmp_eq_u32 s[78:79], s61, v55
  s_and_b64 vcc, vcc, s[78:79]
  s_cmp_eq_u64 vcc, -1
  s_cbranch_scc1 L_h1ok
  s_add_u32 s71, s71, 1
  s_cmp_lt_u32 s71, 262144
  s_cbranch_scc1 L_h1loop
L_h1ok:
  v_cndmask_b32 v22, v22, v21, s[4:5]
  v_cndmask_b32 v30, v30, v29, s[4:5]
  v_max_f32 v35, v36, v38
  s_nop 1
  v_max_f32_dpp v35, v35, v35 row_ror:8 row_mask:0xf bank_mask:0xf
  s_nop 1
  v_max_f32_dpp v35, v35, v35 row_ror:4 row_mask:0xf bank_mask:0xf
  s_nop 1
  v_max_f32_dpp v35, v35, v35 row_ror:2 row_mask:0xf bank_mask:0xf
  s_nop 1
  v_max_f32_dpp v35, v35, v35 row_ror:1 row_mask:0xf bank_mask:0xf
  v_sub_f32 v36, v36, v35
  v_sub_f32 v38, v38, v35
  v_exp_f32 v36, v36
  v_exp_f32 v38, v38
  s_nop 0
  v_add_f32 v44, v36, v38
  v_mul_f32 v40, v36, v16
  v_fmac_f32 v40, v38, v24
  v_mul_f32 v41, v36, v18
  v_fmac_f32 v41, v38, v26
  v_mul_f32 v42, v36, v20
  v_fmac_f32 v42, v38, v28
  v_mul_f32 v43, v36, v22
  v_fmac_f32 v43, v38, v30
  s_nop 1
  v_add_f32_dpp v44, v44, v44 row_ror:8 row_mask:0xf bank_mask:0xf
  v_add_f32_dpp v40, v40, v40 row_ror:8 row_mask:0xf bank_mask:0xf
  v_add_f32_dpp v41, v41, v41 row_ror:8 row_mask:0xf bank_mask:0xf
  v_add_f32_dpp v42, v42, v42 row_ror:8 row_mask:0xf bank_mask:0xf
  v_add_f32_dpp v43, v43, v43 row_ror:8 row_mask:0xf bank_mask:0xf
  v_add_f32_dpp v44, v44, v44 row_ror:4 row_mask:0xf bank_mask:0xf
  v_add_f32_dpp v40, v40, v40 row_ror:4 row_mask:0xf bank_mask:0xf
  v_add_f32_dpp v41, v41, v41 row_ror:4 row_mask:0xf bank_mask:0xf
  v_add_f32_dpp v42, v42, v42 row_ror:4 row_mask:0xf bank_mask:0xf
  v_add_f32_dpp v43, v43, v43 row_ror:4 row_mask:0xf bank_mask:0xf
  v_add_f32_dpp v44, v44, v44 row_ror:2 row_mask:0xf bank_mask:0xf
  v_add_f32_dpp v40, v40, v40 row_ror:2 row_mask:0xf bank_mask:0xf
  v_add_f32_dpp v41, v41, v41 row_ror:2 row_mask:0xf bank_mask:0xf
  v_add_f32_dpp v42, v42, v42 row_ror:2 row_mask:0xf bank_mask:0xf
  v_add_f32_dpp v43, v43, v43 row_ror:2 row_mask:0xf bank_mask:0xf
  v_add_f32_dpp v44, v44, v44 row_ror:1 row_mask:0xf bank_mask:0xf
  v_add_f32_dpp v40, v40, v40 row_ror:1 row_mask:0xf bank_mask:0xf
  v_add_f32_dpp v41, v41, v41 row_ror:1 row_mask:0xf bank_mask:0xf
  v_add_f32_dpp v42, v42, v42 row_ror:1 row_mask:0xf bank_mask:0xf
  v_add_f32_dpp v43, v43, v43 row_ror:1 row_mask:0xf bank_mask:0xf
  v_rcp_f32 v45, v44
  s_nop 0
  v_mul_f32 v32, v40, v45
  v_mul_f32 v33, v41, v45
  v_mul_f32 v34, v42, v45
  v_mul_f32 v35, v43, v45
  v_fma_f32 v36, -v32, v44, v40
  v_fma_f32 v37, -v33, v44, v41
  v_fma_f32 v38, -v34, v44, v42
  v_fma_f32 v39, -v35, v44, v43
  v_fma_f32 v40, v36, v45, v32
  v_fma_f32 v41, v37, v45, v33
  v_fma_f32 v42, v38, v45, v34
  v_fma_f32 v43, v39, v45, v35
  s_mov_b32 exec_lo, 0x00010001
  s_mov_b32 exec_hi, 0x00010001
  ds_write_b128 v1, v[40:43] offset:41088
  s_mov_b64 exec, -1
  s_waitcnt lgkmcnt(0)
L_h1wait:
  v_and_b32 v33, 48, v1
  s_lshl_b32 s72, s2, 7
  s_add_u32 s72, s72, 0x300000
  s_barrier
  ds_read_b128 v[40:43], v33 offset:41088
  s_waitcnt lgkmcnt(0)
  v_cvt_pk_bf16_f32 v40, v40, v40
  v_cvt_pk_bf16_f32 v41, v41, v41
  v_cvt_pk_bf16_f32 v42, v42, v42
  v_cvt_pk_bf16_f32 v43, v43, v43
  v_and_b32 v8, v4, v40
  v_and_b32 v9, v5, v40
  v_and_b32 v10, v6, v40
  v_and_b32 v11, v7, v40
  v_and_b32 v12, v4, v41
  v_and_b32 v13, v5, v41
  v_and_b32 v14, v6, v41
  v_and_b32 v15, v7, v41
  v_and_b32 v16, v4, v42
  v_and_b32 v17, v5, v42
  v_and_b32 v18, v6, v42
  v_and_b32 v19, v7, v42
  v_and_b32 v20, v4, v43
  v_and_b32 v21, v5, v43
  v_and_b32 v22, v6, v43
  v_and_b32 v23, v7, v43
  s_waitcnt vmcnt(0)
  s_nop 1
  v_mfma_f32_16x16x32_bf16 v[36:39], v[8:11], a[128:131], 0
  v_mfma_f32_16x16x32_bf16 v[36:39], v[12:15], a[132:135], v[36:39]
  v_mfma_f32_16x16x32_bf16 v[36:39], v[16:19], a[136:139], v[36:39]
  v_mfma_f32_16x16x32_bf16 v[36:39], v[20:23], a[140:143], v[36:39]
  s_nop 7
  v_permlane32_swap_b32 v36, v38
  v_permlane32_swap_b32 v37, v39
  v_mov_b32 v25, v59
  v_mov_b32 v27, v59
  v_mov_b32 v24, v36
  v_mov_b32 v26, v37
  s_mov_b64 exec, s[68:69]
  buffer_store_dwordx4 v[24:27], v56, s[36:39], s72 offen sc1
  s_mov_b64 exec, -1
  s_cmp_ge_u32 s2, 28
  s_cbranch_scc1 L_fin
  s_lshl_b32 s72, s3, 13
  s_lshl_b32 s73, s2, 15
  s_add_u32 s72, s72, s73
  s_add_u32 s72, s72, 0x300000
  s_add_u32 s73, s72, 4096
  v_lshrrev_b32 v44, 4, v1
  v_lshlrev_b32 v44, 7, v44
  v_and_b32 v45, 7, v1
  v_lshl_add_u32 v44, v45, 4, v44
  s_lshl_b32 s74, s3, 9
  v_add_u32 v44, s74, v44
  s_mov_b32 s71, 0
L_h2loop:
  buffer_load_dwordx4 v[8:11], v63, s[36:39], s72 offen offset:0 sc1
  buffer_load_dwordx4 v[12:15], v63, s[36:39], s72 offen offset:1024 sc1
  buffer_load_dwordx4 v[16:19], v63, s[36:39], s72 offen offset:2048 sc1
  buffer_load_dwordx4 v[20:23], v63, s[36:39], s72 offen offset:3072 sc1
  buffer_load_dwordx4 v[24:27], v63, s[36:39], s73 offen offset:0 sc1
  buffer_load_dwordx4 v[28:31], v63, s[36:39], s73 offen offset:1024 sc1
  buffer_load_dwordx4 v[32:35], v63, s[36:39], s73 offen offset:2048 sc1
  buffer_load_dwordx4 v[36:39], v63, s[36:39], s73 offen offset:3072 sc1
  s_waitcnt vmcnt(0)
  v_min3_u32 v54, v9, v11, v13
  v_max3_u32 v55, v9, v11, v13
  v_min3_u32 v54, v54, v15, v17
  v_max3_u32 v55, v55, v15, v17
  v_min3_u32 v54, v54, v19, v21
  v_max3_u32 v55, v55, v19, v21
  v_min3_u32 v54, v54, v23, v25
  v_max3_u32 v55, v55, v23, v25
  v_min3_u32 v54, v54, v27, v29
  v_max3_u32 v55, v55, v27, v29
  v_min3_u32 v54, v54, v31, v33
  v_max3_u32 v55, v55, v31, v33
  v_min3_u32 v54, v54, v35, v37
  v_max3_u32 v55, v55, v35, v37
  v_min_u32 v54, v54, v39
  v_max_u32 v55, v55, v39
  v_cmp_eq_u32 vcc, s61, v54
  v_cmp_eq_u32 s[78:79], s61, v55
  s_and_b64 vcc, vcc, s[78:79]
  s_cmp_eq_u64 vcc, -1
  s_cbranch_scc1 L_h2ok
  s_add_u32 s71, s71, 1
  s_cmp_lt_u32 s71, 262144
  s_cbranch_scc1 L_h2loop
L_h2ok:
  v_add_f32 v8, v8, v24
  v_add_f32 v10, v10, v26
  v_add_f32 v12, v12, v28
  v_add_f32 v14, v14, v30
  v_add_f32 v16, v16, v32
  v_add_f32 v18, v18, v34
  v_add_f32 v20, v20, v36
  v_add_f32 v22, v22, v38
  v_add_f32 v8, v8, v16
  v_add_f32 v10, v10, v18
  v_add_f32 v12, v12, v20
  v_add_f32 v14, v14, v22
  v_add_f32 v8, v8, v12
  v_add_f32 v10, v10, v14
  v_mov_b32 v40, v8
  v_mov_b32 v41, v10
  v_mov_b32 v42, v46
  v_mov_b32 v43, v47
  s_nop 1
  v_add_f32_dpp v40, v40, v40 row_ror:8 row_mask:0xf bank_mask:0xf
  v_add_f32_dpp v41, v41, v41 row_ror:8 row_mask:0xf bank_mask:0xf
  v_add_f32_dpp v42, v42, v42 row_ror:8 row_mask:0xf bank_mask:0xf
  v_add_f32_dpp v43, v43, v43 row_ror:8 row_mask:0xf bank_mask:0xf
  s_mov_b32 exec_lo, 0x00ff00ff
  s_mov_b32 exec_hi, 0x00ff00ff
  ds_write_b128 v44, v[40:43] offset:41216
  s_mov_b64 exec, -1
  s_waitcnt lgkmcnt(0)
  s_barrier
  s_cmp_lg_u32 s3, 0
  s_cbranch_scc1 L_fin
  ds_read_b128 v[40:43], v63 offset:41216
  ds_read_b128 v[8:11], v63 offset:42240
  s_waitcnt lgkmcnt(0)
  v_add_f32 v40, v40, v8
  v_add_f32 v41, v41, v9
  v_add_f32 v42, v42, v10
  v_add_f32 v43, v43, v11
  s_nop 1
  v_add_f32_dpp v40, v40, v40 row_ror:8 row_mask:0xf bank_mask:0xf
  v_add_f32_dpp v41, v41, v41 row_ror:8 row_mask:0xf bank_mask:0xf
  v_add_f32_dpp v42, v42, v42 row_ror:8 row_mask:0xf bank_mask:0xf
  v_add_f32_dpp v43, v43, v43 row_ror:8 row_mask:0xf bank_mask:0xf
  v_mov_b32 v8, v40
  v_mov_b32 v9, v41
  v_mov_b32 v10, v42
  v_mov_b32 v11, v43
  s_nop 1
  v_permlane16_swap_b32 v8, v40
  v_permlane16_swap_b32 v9, v41
  v_permlane16_swap_b32 v10, v42
  v_permlane16_swap_b32 v11, v43
  s_nop 1
  v_add_f32 v40, v40, v8
  v_add_f32 v41, v41, v9
  v_add_f32 v42, v42, v10
  v_add_f32 v43, v43, v11
  v_mov_b32 v8, v40
  v_mov_b32 v9, v41
  v_mov_b32 v10, v42
  v_mov_b32 v11, v43
  s_nop 1
  v_permlane32_swap_b32 v8, v40
  v_permlane32_swap_b32 v9, v41
  v_permlane32_swap_b32 v10, v42
  v_permlane32_swap_b32 v11, v43
  s_nop 1
  v_add_f32 v40, v40, v8
  v_add_f32 v41, v41, v9
  v_add_f32 v42, v42, v10
  v_add_f32 v43, v43, v11
  v_cvt_pk_bf16_f32 v40, v40, v40
  v_and_b32 v40, 0xffff0000, v40
  v_cvt_pk_bf16_f32 v41, v41, v41
  v_and_b32 v41, 0xffff0000, v41
  v_cvt_pk_bf16_f32 v42, v42, v42
  v_and_b32 v42, 0xffff0000, v42
  v_cvt_pk_bf16_f32 v43, v43, v43
  v_and_b32 v43, 0xffff0000, v43
  v_lshlrev_b32 v44, 16, v57
  v_and_b32 v8, 0xffff0000, v57
  v_add_f32 v44, v44, v40
  v_add_f32 v8, v8, v41
  v_cvt_pk_bf16_f32 v44, v44, v44
  v_and_b32 v44, 0xffff0000, v44
  v_cvt_pk_bf16_f32 v8, v8, v8
  v_and_b32 v8, 0xffff0000, v8
  v_add_f32 v44, v44, v42
  v_add_f32 v8, v8, v43
  v_cvt_pk_bf16_f32 v44, v44, v8
  v_lshlrev_b32 v45, 2, v45
  s_lshl_b32 s73, s2, 5
  s_mov_b32 exec_lo, 0xff
  s_mov_b32 exec_hi, 0
  buffer_store_dword v44, v45, s[52:55], s73 offen
  s_cmp_lg_u32 s2, 0
  s_cbranch_scc1 L_noep
  s_add_u32 s72, s60, 1
  v_mov_b32 v45, s72
  s_mov_b32 exec_lo, 1
  buffer_store_dword v45, v61, s[36:39], 0 offen offset:0
L_noep:
  s_mov_b64 exec, -1
L_fin:
L_end:
  s_endpgm
.section .rodata,"a"
.p2align 6
.amdhsa_kernel parallel_sum__gqa_block_cached__swiglu_ffn__decode_kernel
  .amdhsa_next_free_vgpr 256
  .amdhsa_next_free_sgpr 102
  .amdhsa_accum_offset 64
  .amdhsa_group_segment_fixed_size 0
  .amdhsa_kernarg_size 96
  .amdhsa_user_sgpr_count 2
  .amdhsa_user_sgpr_kernarg_segment_ptr 1
  .amdhsa_system_sgpr_workgroup_id_x 1
  .amdhsa_float_denorm_mode_32 3
.end_amdhsa_kernel
```
